```python
import torch

def _softmax(x, axis=-1):
    return torch.softmax(x, dim=axis)
def _gelu(x):
    return torch.nn.functional.gelu(x, approximate="tanh")
def _silu(x):
    return torch.nn.functional.silu(x)
def _sigmoid(x):
    return torch.sigmoid(x)
def _layernorm(x, axis=-1, eps=1e-5):
    m = x.mean(dim=axis, keepdim=True)
    v = x.var(dim=axis, keepdim=True, unbiased=False)
    return (x - m) / torch.sqrt(v + eps)
def _scatter_add(tgt, idx, src, axis=0):
    return tgt.clone().index_add_(axis, idx, src)
def _segment_sum(src, seg, n):
    out = torch.zeros((n,) + src.shape[1:], dtype=src.dtype)
    return out.index_add_(0, seg, src)
def _pad(x, pw):
    flat = tuple(v for pair in reversed(pw) for v in pair)
    return torch.nn.functional.pad(x, flat)

kernel_name = 'standalone__mha_block__prompt'

def setup_inputs():

    _w = (lambda a: (lambda t: t.to(torch.bfloat16) if t.is_floating_point() else t)(torch.as_tensor(a)))
    B, S, D, H = 1, 2048, 1024, 32
    return {
        "x": _w((lambda *s: torch.randn(*s, dtype=torch.bfloat16) * 0.2)(B, S, D)),
        "wqkv": _w((lambda *s: torch.randn(*s, dtype=torch.bfloat16) * 0.2)(D, 3 * D)),
        "wo": _w((lambda *s: torch.randn(*s, dtype=torch.bfloat16) * 0.05)(D, D)),
    }

def reference(x, wqkv, wo):
    B, S, D = x.shape
    H = 32
    Dh = D // H
    qkv = (lambda x, *d: x.permute(*d))((x @ wqkv).reshape(B, S, 3, H, Dh), 2, 0, 3, 1, 4)
    q, k, v = qkv[0], qkv[1], qkv[2]
    scores = torch.einsum("bhqd,bhkd->bhqk", q, k) * (Dh ** -0.5)
    p = _softmax(scores, axis=-1)
    o = torch.einsum("bhqk,bhkd->bhqd", p, v)
    return (lambda x, *d: x.permute(*d))(o, 0, 2, 1, 3).reshape(B, S, D) @ wo
```

```asm
; @launch grid=(256,1,1) block=(512,1,1) lds=163840
.amdgcn_target "amdgcn-amd-amdhsa--gfx950"
.text
.globl standalone__mha_block__prompt_kernel
.p2align 8
.type standalone__mha_block__prompt_kernel,@function
standalone__mha_block__prompt_kernel:
  s_cmp_ge_u32 s2, 256
  s_cbranch_scc1 K_END
  s_load_dwordx8 s[4:11], s[0:1], 0
  s_load_dwordx4 s[12:15], s[0:1], 32
  v_lshrrev_b32 v1, 6, v0
  v_and_b32 v0, 63, v0
  s_and_b32 s47, s2, 7
  v_readfirstlane_b32 s18, v1
  s_lshr_b32 s48, s2, 3
  s_lshr_b32 s16, s47, 1
  s_lshl_b32 s16, s16, 2
  s_add_u32 s49, s48, 0
  s_and_b32 s49, s49, 3
  s_add_u32 s16, s16, s49
  s_xor_b32 s16, s16, 0
  s_and_b32 s17, s47, 1
  s_lshl_b32 s17, s17, 3
  s_lshr_b32 s49, s48, 2
  s_add_u32 s17, s17, s49
  s_xor_b32 s17, s17, 8
  s_xor_b32 s18, s18, 4
  s_cmp_lt_u32 s18, 4
  s_cbranch_scc1 P1_COMPUTE
  s_sub_u32 s47, s18, 4
  v_lshrrev_b32 v1, 3, v0
  v_and_b32 v2, 7, v0
  v_lshrrev_b32 v3, 4, v0
  v_xor_b32 v2, v2, v3
  s_lshl_b32 s48, s47, 5
  v_add_u32 v8, s48, v1
  v_lshlrev_b32 v8, 11, v8
  v_lshlrev_b32 v9, 4, v2
  v_add_u32 v4, v8, v9
  v_xor_b32 v9, 64, v9
  v_add_u32 v5, v8, v9
  v_add_u32 v5, 15360, v5
  v_add_u32 v6, 30720, v4
  v_add_u32 v7, 30720, v5
  s_lshl_b32 s67, s47, 12
  s_and_b32 s49, s2, 1
  s_mul_i32 s52, s49, 0
  s_bfe_u32 s49, s2, 0x20001
  s_mul_i32 s49, s49, 0
  s_add_u32 s52, s52, s49
  s_lshr_b32 s49, s2, 5
  s_mul_i32 s51, s49, 0
  s_bfe_u32 s49, s2, 0x20003
  s_mul_i32 s49, s49, 0
  s_add_u32 s51, s51, s49
  s_and_b32 s54, s51, 15
  s_add_u32 s54, s54, s52
  s_mov_b32 s50, 0
  s_mov_b32 s92, 4294967295
  s_mov_b32 s93, 4294967295
  s_and_b32 s54, s54, 15
  s_mul_i32 s55, s54, 393216
  s_lshl_b32 s54, s54, 7
  s_mov_b32 s53, 0
  s_mov_b32 m0, s67
  s_lshl_b32 s48, s17, 18
  s_mov_b32 s26, 262144
  s_mov_b32 s27, 0x20000
  v_lshrrev_b32 v2, 2, v0
  v_xor_b32 v2, v2, v3
  v_and_b32 v2, 1, v2
  v_lshlrev_b32 v2, 6, v2
  v_and_b32 v3, 3, v0
  v_lshl_add_u32 v2, v3, 4, v2
  s_lshl_b32 s49, s47, 4
  v_add_u32 v3, s49, v1
  v_mul_u32_u24 v3, 6144, v3
  s_mul_i32 s90, s47, 6144
  s_add_u32 s90, s90, 16384
  s_lshl_b32 s49, s16, 7
  s_sub_u32 s30, 6291456, s49
  s_mov_b32 s31, 0x20000
  s_waitcnt lgkmcnt(0)
  s_add_u32 s24, s4, s48
  s_addc_u32 s25, s5, 0
  s_and_b32 s25, s25, 0xffff
  buffer_load_dwordx4 v4, s[24:27], s54 offen offset:0 lds
  buffer_load_dwordx4 v5, s[24:27], s54 offen offset:1024 lds
  buffer_load_dwordx4 v6, s[24:27], s54 offen offset:2048 lds
  buffer_load_dwordx4 v7, s[24:27], s54 offen offset:3072 lds
  s_add_u32 s28, s6, s49
  s_addc_u32 s29, s7, 0
  s_and_b32 s29, s29, 0xffff
  v_add_u32 v10, v2, v3
  v_xor_b32 v2, 32, v2
  v_add_u32 v11, v2, v3
  v_add_u32 v11, 48128, v11
  v_add_u32 v12, 4096, v10
  v_add_u32 v13, 4096, v11
  s_add_u32 m0, s53, s90
  s_add_u32 s50, s50, 1
  buffer_load_dwordx4 v10, s[28:31], s55 offen offset:0 lds
  buffer_load_dwordx4 v11, s[28:31], s55 offen offset:1024 lds
  buffer_load_dwordx4 v10, s[28:31], s55 offen offset:2048 lds
  buffer_load_dwordx4 v11, s[28:31], s55 offen offset:3072 lds
  s_add_u32 m0, m0, 4096
  s_add_u32 s53, s53, 40960
  buffer_load_dwordx4 v12, s[28:31], s55 offen offset:0 lds
  buffer_load_dwordx4 v13, s[28:31], s55 offen offset:1024 lds
  s_lshl_b32 s88, s50, 2
  s_lshr_b64 s[88:89], s[92:93], s88
  s_and_b32 s88, s88, 15
  s_add_u32 s54, s50, s51
  s_and_b32 s54, s54, s88
  s_andn2_b32 s55, s50, s88
  s_add_u32 s54, s54, s55
  s_add_u32 s54, s54, s52
  s_and_b32 s54, s54, 15
  s_mul_i32 s55, s54, 393216
  s_lshl_b32 s54, s54, 7
  s_cmp_eq_u32 s53, 163840
  s_cselect_b32 s53, 0, s53
  s_add_u32 m0, s53, s67
  s_nop 0
  buffer_load_dwordx4 v4, s[24:27], s54 offen offset:0 lds
  buffer_load_dwordx4 v5, s[24:27], s54 offen offset:1024 lds
  buffer_load_dwordx4 v6, s[24:27], s54 offen offset:2048 lds
  buffer_load_dwordx4 v7, s[24:27], s54 offen offset:3072 lds
  s_add_u32 m0, s53, s90
  s_add_u32 s50, s50, 1
  buffer_load_dwordx4 v10, s[28:31], s55 offen offset:0 lds
  buffer_load_dwordx4 v11, s[28:31], s55 offen offset:1024 lds
  buffer_load_dwordx4 v10, s[28:31], s55 offen offset:2048 lds
  buffer_load_dwordx4 v11, s[28:31], s55 offen offset:3072 lds
  s_add_u32 m0, m0, 4096
  s_add_u32 s53, s53, 40960
  buffer_load_dwordx4 v12, s[28:31], s55 offen offset:0 lds
  buffer_load_dwordx4 v13, s[28:31], s55 offen offset:1024 lds
  s_lshl_b32 s88, s50, 2
  s_lshr_b64 s[88:89], s[92:93], s88
  s_and_b32 s88, s88, 15
  s_add_u32 s54, s50, s51
  s_and_b32 s54, s54, s88
  s_andn2_b32 s55, s50, s88
  s_add_u32 s54, s54, s55
  s_add_u32 s54, s54, s52
  s_and_b32 s54, s54, 15
  s_mul_i32 s55, s54, 393216
  s_lshl_b32 s54, s54, 7
  s_cmp_eq_u32 s53, 163840
  s_cselect_b32 s53, 0, s53
  v_mov_b32 v18, 0
  v_mov_b32 v16, 0
  v_mov_b32 v17, 0
  s_cmp_lg_u32 s2, 0
  s_cbranch_scc1 P1_NONON
  s_cmp_lg_u32 s18, 7
  s_cbranch_scc1 P1_NONON
  s_memrealtime s[64:65]
  s_waitcnt lgkmcnt(0)
  s_or_b32 s64, s64, 1
  v_mov_b32 v20, s64
  v_mov_b32 v21, s65
  global_store_dwordx2 v18, v[20:21], s[12:13] sc1
P1_NONON:
  s_mov_b32 s91, 0
P1_LLOOP:
  s_waitcnt vmcnt(10)
  s_barrier
  s_cmp_lg_u32 s18, 7
  s_cbranch_scc1 P1_NONSKIP
  s_cmp_lg_u32 s91, 8
  s_cbranch_scc1 P1_NONSKIP
  global_load_dwordx2 v[16:17], v18, s[12:13] sc1
P1_NONSKIP:
  s_add_u32 m0, s53, s67
  s_nop 0
  buffer_load_dwordx4 v4, s[24:27], s54 offen offset:0 lds
  buffer_load_dwordx4 v5, s[24:27], s54 offen offset:1024 lds
  buffer_load_dwordx4 v6, s[24:27], s54 offen offset:2048 lds
  buffer_load_dwordx4 v7, s[24:27], s54 offen offset:3072 lds
  s_add_u32 m0, s53, s90
  s_add_u32 s50, s50, 1
  buffer_load_dwordx4 v10, s[28:31], s55 offen offset:0 lds
  buffer_load_dwordx4 v11, s[28:31], s55 offen offset:1024 lds
  buffer_load_dwordx4 v10, s[28:31], s55 offen offset:2048 lds
  buffer_load_dwordx4 v11, s[28:31], s55 offen offset:3072 lds
  s_add_u32 m0, m0, 4096
  s_add_u32 s53, s53, 40960
  buffer_load_dwordx4 v12, s[28:31], s55 offen offset:0 lds
  buffer_load_dwordx4 v13, s[28:31], s55 offen offset:1024 lds
  s_lshl_b32 s88, s50, 2
  s_lshr_b64 s[88:89], s[92:93], s88
  s_and_b32 s88, s88, 15
  s_add_u32 s54, s50, s51
  s_and_b32 s54, s54, s88
  s_andn2_b32 s55, s50, s88
  s_add_u32 s54, s54, s55
  s_add_u32 s54, s54, s52
  s_and_b32 s54, s54, 15
  s_mul_i32 s55, s54, 393216
  s_lshl_b32 s54, s54, 7
  s_cmp_eq_u32 s53, 163840
  s_cselect_b32 s53, 0, s53
  s_add_u32 s91, s91, 1
  s_cmp_lt_u32 s91, 14
  s_cbranch_scc1 P1_LLOOP
  s_waitcnt vmcnt(10)
  s_barrier
  s_waitcnt vmcnt(0)
  s_barrier
  s_cmp_lg_u32 s18, 7
  s_cbranch_scc1 P1_NONDONE
  s_mov_b32 s66, 0
P1_NONPOLL:
  v_readfirstlane_b32 s64, v16
  v_readfirstlane_b32 s65, v17
  s_add_u32 s66, s66, 1
  s_cmp_ge_u32 s66, 131072
  s_cbranch_scc1 P1_NONDONE
  s_cmp_eq_u32 s64, 0
  s_cbranch_scc0 P1_NONDONE
  s_sleep 2
  global_load_dwordx2 v[16:17], v18, s[12:13] sc1
  s_waitcnt vmcnt(0)
  s_branch P1_NONPOLL
P1_NONDONE:
  s_barrier
  s_and_b32 s47, s2, 7
  s_lshr_b32 s48, s2, 3
  s_and_b32 s45, s47, 6
  s_and_b32 s49, 1, s47
  s_lshl3_add_u32 s45, s49, s45
  s_and_b32 s49, s48, 1
  s_add_u32 s45, s45, s49
  s_lshr_b32 s46, s48, 1
  s_and_b32 s87, s46, 3
  s_lshl_b32 s87, s87, 2
  s_and_b32 s19, s18, 1
  s_lshr_b32 s44, s18, 1
  s_and_b32 s44, s44, 1
  s_mov_b32 s20, s14
  s_and_b32 s21, s15, 0xffff
  s_mov_b32 s22, 16777216
  s_mov_b32 s23, 0x20000
  s_mov_b32 s40, s14
  s_and_b32 s41, s15, 0xffff
  s_mov_b32 s42, 16777216
  s_mov_b32 s43, 0x20000
  s_mov_b32 s32, s10
  s_and_b32 s33, s11, 0xffff
  s_mov_b32 s34, 4194304
  s_mov_b32 s35, 0x20000
  s_lshl_b32 s47, s46, 7
  s_add_u32 s36, s8, s47
  s_addc_u32 s37, s9, 0
  s_and_b32 s37, s37, 0xffff
  s_sub_u32 s38, 2097152, s47
  s_mov_b32 s39, 0x20000
  s_lshr_b32 s47, s18, 2
  s_lshl_b32 s48, s16, 1
  s_add_u32 s49, s48, s47
  s_lshl_b32 s49, s49, 18
  s_and_b32 s50, s18, 3
  s_lshl_b32 s51, s50, 12
  s_add_u32 s59, s49, s51
  s_lshl_b32 s61, s18, 12
  s_mov_b32 s58, 16384
  s_lshl_b32 s63, 1, s17
  s_xor_b32 s57, s63, 0xffff
  s_mov_b32 s56, 0
  s_mov_b32 s62, 0x8000
  s_lshl_b32 s49, s44, 1
  s_add_u32 s51, s49, s47
  s_lshl_b32 s52, s16, 2
  s_add_u32 s51, s51, s52
  s_lshl_b32 s51, s51, 7
  s_add_u32 s24, s51, 12582912
  s_add_u32 s51, s49, s19
  s_add_u32 s51, s51, s52
  s_lshl_b32 s51, s51, 7
  s_lshl_b32 s52, s17, 3
  s_add_u32 s51, s51, s52
  s_add_u32 s25, s51, 12582912
  s_lshl_b32 s51, s17, 2
  s_add_u32 s51, s51, s49
  s_add_u32 s51, s51, s47
  s_add_u32 s48, s48, s19
  s_lshl_b32 s52, s51, 16
  s_lshl_b32 s49, s48, 11
  s_add_u32 s52, s52, s49
  s_add_u32 s26, s52, 8388608
  s_lshl_b32 s51, s51, 1
  s_lshr_b32 s52, s16, 1
  s_and_b32 s52, s52, 1
  s_add_u32 s51, s51, s52
  s_lshl_b32 s51, s51, 4
  s_and_b32 s52, s16, 12
  s_add_u32 s51, s51, s52
  s_and_b32 s52, s48, 3
  s_add_u32 s51, s51, s52
  s_lshl_b32 s51, s51, 3
  s_add_u32 s27, s51, 13107200
  s_lshl_b32 s51, s45, 2
  s_add_u32 s51, s51, s50
  s_lshl_b32 s52, s51, 1
  s_add_u32 s52, s52, s47
  s_lshl_b32 s52, s52, 7
  s_add_u32 s28, s52, 13107200
  s_lshl_b32 s51, s51, 16
  s_lshl_b32 s52, s47, 13
  s_add_u32 s51, s51, s52
  s_add_u32 s29, s51, 8388608
  v_lshlrev_b32 v3, 4, v0
  v_lshrrev_b32 v164, 3, v0
  v_lshrrev_b32 v165, 2, v0
  v_lshrrev_b32 v166, 4, v0
  v_xor_b32 v168, v165, v166
  v_and_b32 v168, 1, v168
  v_lshlrev_b32 v165, 6, v168
  v_and_b32 v166, 3, v0
  v_lshl_add_u32 v165, v166, 4, v165
  s_lshl_b32 s47, s18, 5
  v_add_u32 v164, s47, v164
  v_lshl_add_u32 v164, v164, 11, v165
  v_add_u32 v165, 15360, v164
  v_add_u32 v166, 30720, v164
  v_add_u32 v167, 46080, v164
  v_mov_b32 v160, v3
  v_mov_b32 v161, v3
  v_mov_b32 v162, v3
  v_mov_b32 v163, v3
  v_cmp_eq_u32 vcc, 0, v168
  v_mov_b32 v169, 0x3f803f80
  s_lshl_b32 s47, s19, 14
  v_add_u32 v173, s47, v3
  v_cndmask_b32 v168, 0, v169, vcc
  s_and_b32 s47, s18, 3
  s_lshl_b32 s47, s47, 11
  s_add_u32 s47, s47, 65536
  v_add_u32 v172, s47, v3
  v_mov_b32 v178, 73728
  s_lshr_b32 s47, s2, 3
  s_lshl_b32 s47, s47, 3
  s_add_u32 s47, s47, s18
  s_lshl_b32 s47, s47, 13
  v_lshlrev_b32 v179, 7, v0
  v_add_u32 v179, s47, v179
  s_lshr_b32 s94, s18, 1
  s_add_u32 s94, s94, 6
  v_mov_b32 v169, v168
  v_mov_b32 v170, v168
  v_mov_b32 v171, v168
  v_and_b32 v175, 4, v0
  v_cmp_eq_u32 vcc, 0, v175
  v_mov_b32 v170, 0x3f803f80
  v_and_b32 v175, 1, v0
  v_cndmask_b32 v168, 0, v170, vcc
  v_cndmask_b32 v169, 0, v170, vcc
  v_cmp_eq_u32 vcc, 0, v175
  v_xor_b32 v170, v170, v168
  v_mov_b32 v175, 0x44444444
  v_mov_b32 v171, 0xeeeeeeee
  v_cndmask_b32 v175, v171, v175, vcc
  v_mov_b32 v171, v170
  s_cmp_lg_u32 s18, 7
  s_cbranch_scc1 P2_START
  ds_write_b64 v178, v[16:17]
  s_branch P2_START
P1_COMPUTE:
  s_and_b32 s47, s2, 7
  s_lshr_b32 s49, s2, 3
  s_and_b32 s50, s47, 1
  s_xor_b32 s50, s50, 1
  s_lshr_b32 s48, s47, 1
  s_mul_i32 s94, s50, 0
  s_mul_i32 s51, s48, 0
  s_add_u32 s94, s94, s51
  s_and_b32 s94, s94, 15
  v_min_u32 v201, 47, v0
  v_lshrrev_b32 v200, 2, v201
  s_lshl_b32 s51, s50, 5
  s_add_u32 s51, s51, s49
  s_mul_i32 s51, s51, 12
  v_add_u32 v200, s51, v200
  v_lshlrev_b32 v200, 11, v200
  v_and_b32 v201, 3, v201
  v_lshl_add_u32 v200, v201, 7, v200
  s_lshl_b32 s51, s48, 9
  v_add_u32 v200, s51, v200
  s_lshl_b32 s51, s50, 10
  s_lshl_b32 s52, s48, 8
  s_add_u32 s51, s51, s52
  s_lshl_b32 s52, s49, 3
  s_add_u32 s51, s51, s52
  v_lshrrev_b32 v203, 3, v0
  v_add_u32 v203, s51, v203
  v_lshlrev_b32 v203, 11, v203
  v_and_b32 v204, 7, v0
  v_lshl_add_u32 v201, v204, 7, v203
  v_lshrrev_b32 v204, 1, v204
  v_lshl_add_u32 v202, v204, 7, v203
  s_mov_b32 s100, 99
  s_mov_b32 s101, 99
  v_mov_b32 v203, v200
  v_mov_b32 v204, v200
  s_waitcnt lgkmcnt(0)
  s_mov_b32 s88, s6
  s_mov_b32 s89, s7
  s_cmp_lg_u32 s18, 0
  s_cbranch_scc1 PFJ0
  v_add_u32 v203, 786432, v200
  s_mov_b32 s100, 0
  v_add_u32 v204, 3932160, v200
  s_mov_b32 s101, 2
PFJ0:
  s_cmp_lg_u32 s18, 1
  s_cbranch_scc1 PFJ1
  v_add_u32 v203, 2359296, v200
  s_mov_b32 s100, 0
  v_add_u32 v204, 4718592, v200
  s_mov_b32 s101, 4
PFJ1:
  s_cmp_lg_u32 s18, 2
  s_cbranch_scc1 PFJ2
  v_add_u32 v203, 256, v202
  s_mov_b32 s100, 0
  v_add_u32 v204, 1280, v202
  s_mov_b32 s101, 2
  s_mov_b32 s88, s4
  s_mov_b32 s89, s5
PFJ2:
  s_cmp_lg_u32 s18, 3
  s_cbranch_scc1 PFJ3
  v_add_u32 v203, 768, v202
  s_mov_b32 s100, 0
  v_add_u32 v204, 1536, v202
  s_mov_b32 s101, 4
  s_mov_b32 s88, s4
  s_mov_b32 s89, s5
PFJ3:
  s_setprio 1
  s_and_b32 s19, s18, 1
  s_lshr_b32 s44, s18, 1
  v_and_b32 v1, 15, v0
  v_lshrrev_b32 v2, 4, v0
  v_lshrrev_b32 v3, 1, v1
  v_xor_b32 v3, v3, v2
  s_lshl_b32 s47, s44, 6
  v_add_u32 v1, s47, v1
  v_lshlrev_b32 v1, 7, v1
  v_lshl_add_u32 v4, v3, 4, v1
  v_xor_b32 v5, 64, v4
  v_lshrrev_b32 v1, 2, v0
  v_and_b32 v1, 3, v1
  v_and_b32 v3, 1, v2
  v_lshl_add_u32 v9, v3, 3, v1
  v_lshlrev_b32 v9, 7, v9
  v_lshrrev_b32 v8, 1, v2
  v_mul_u32_u24 v8, 6144, v8
  v_add_u32 v9, v9, v8
  v_and_b32 v1, 2, v1
  v_or_b32 v1, v1, v3
  s_lshl_b32 s47, s19, 1
  v_xor_b32 v1, s47, v1
  v_lshl_add_u32 v9, v1, 5, v9
  v_and_b32 v1, 3, v0
  v_lshl_add_u32 v9, v1, 3, v9
  v_add_u32 v6, 16384, v9
  v_xor_b32 v7, 32, v6
  v_mov_b32 v64, 0
  v_mov_b32 v65, 0
  v_mov_b32 v66, 0
  v_mov_b32 v67, 0
  v_mov_b32 v68, 0
  v_mov_b32 v69, 0
  v_mov_b32 v70, 0
  v_mov_b32 v71, 0
  v_mov_b32 v72, 0
  v_mov_b32 v73, 0
  v_mov_b32 v74, 0
  v_mov_b32 v75, 0
  v_mov_b32 v76, 0
  v_mov_b32 v77, 0
  v_mov_b32 v78, 0
  v_mov_b32 v79, 0
  v_mov_b32 v80, 0
  v_mov_b32 v81, 0
  v_mov_b32 v82, 0
  v_mov_b32 v83, 0
  v_mov_b32 v84, 0
  v_mov_b32 v85, 0
  v_mov_b32 v86, 0
  v_mov_b32 v87, 0
  v_mov_b32 v88, 0
  v_mov_b32 v89, 0
  v_mov_b32 v90, 0
  v_mov_b32 v91, 0
  v_mov_b32 v92, 0
  v_mov_b32 v93, 0
  v_mov_b32 v94, 0
  v_mov_b32 v95, 0
  v_mov_b32 v96, 0
  v_mov_b32 v97, 0
  v_mov_b32 v98, 0
  v_mov_b32 v99, 0
  v_mov_b32 v100, 0
  v_mov_b32 v101, 0
  v_mov_b32 v102, 0
  v_mov_b32 v103, 0
  v_mov_b32 v104, 0
  v_mov_b32 v105, 0
  v_mov_b32 v106, 0
  v_mov_b32 v107, 0
  v_mov_b32 v108, 0
  v_mov_b32 v109, 0
  v_mov_b32 v110, 0
  v_mov_b32 v111, 0
  v_mov_b32 v112, 0
  v_mov_b32 v113, 0
  v_mov_b32 v114, 0
  v_mov_b32 v115, 0
  v_mov_b32 v116, 0
  v_mov_b32 v117, 0
  v_mov_b32 v118, 0
  v_mov_b32 v119, 0
  v_mov_b32 v120, 0
  v_mov_b32 v121, 0
  v_mov_b32 v122, 0
  v_mov_b32 v123, 0
  v_mov_b32 v124, 0
  v_mov_b32 v125, 0
  v_mov_b32 v126, 0
  v_mov_b32 v127, 0
  v_mov_b32 v128, 0
  v_mov_b32 v129, 0
  v_mov_b32 v130, 0
  v_mov_b32 v131, 0
  v_mov_b32 v132, 0
  v_mov_b32 v133, 0
  v_mov_b32 v134, 0
  v_mov_b32 v135, 0
  v_mov_b32 v136, 0
  v_mov_b32 v137, 0
  v_mov_b32 v138, 0
  v_mov_b32 v139, 0
  v_mov_b32 v140, 0
  v_mov_b32 v141, 0
  v_mov_b32 v142, 0
  v_mov_b32 v143, 0
  v_mov_b32 v144, 0
  v_mov_b32 v145, 0
  v_mov_b32 v146, 0
  v_mov_b32 v147, 0
  v_mov_b32 v148, 0
  v_mov_b32 v149, 0
  v_mov_b32 v150, 0
  v_mov_b32 v151, 0
  v_mov_b32 v152, 0
  v_mov_b32 v153, 0
  v_mov_b32 v154, 0
  v_mov_b32 v155, 0
  v_mov_b32 v156, 0
  v_mov_b32 v157, 0
  v_mov_b32 v158, 0
  v_mov_b32 v159, 0
  s_and_b32 s47, s2, 7
  s_lshr_b32 s48, s2, 3
  s_and_b32 s45, s47, 6
  s_and_b32 s49, 1, s47
  s_lshl3_add_u32 s45, s49, s45
  s_and_b32 s49, s48, 1
  s_add_u32 s45, s45, s49
  s_lshr_b32 s46, s48, 1
  s_and_b32 s87, s46, 3
  s_lshl_b32 s87, s87, 2
  s_and_b32 s19, s18, 1
  s_lshr_b32 s44, s18, 1
  s_and_b32 s44, s44, 1
  s_mov_b32 s20, s14
  s_and_b32 s21, s15, 0xffff
  s_mov_b32 s22, 16777216
  s_mov_b32 s23, 0x20000
  s_mov_b32 s40, s14
  s_and_b32 s41, s15, 0xffff
  s_mov_b32 s42, 16777216
  s_mov_b32 s43, 0x20000
  s_mov_b32 s32, s10
  s_and_b32 s33, s11, 0xffff
  s_mov_b32 s34, 4194304
  s_mov_b32 s35, 0x20000
  s_lshl_b32 s47, s46, 7
  s_add_u32 s36, s8, s47
  s_addc_u32 s37, s9, 0
  s_and_b32 s37, s37, 0xffff
  s_sub_u32 s38, 2097152, s47
  s_mov_b32 s39, 0x20000
  s_lshr_b32 s47, s18, 2
  s_lshl_b32 s48, s16, 1
  s_add_u32 s49, s48, s47
  s_lshl_b32 s49, s49, 18
  s_and_b32 s50, s18, 3
  s_lshl_b32 s51, s50, 12
  s_add_u32 s59, s49, s51
  s_lshl_b32 s61, s18, 12
  s_mov_b32 s58, 16384
  s_lshl_b32 s63, 1, s17
  s_xor_b32 s57, s63, 0xffff
  s_mov_b32 s56, 0
  s_mov_b32 s62, 0x8000
  s_lshl_b32 s49, s44, 1
  s_add_u32 s51, s49, s47
  s_lshl_b32 s52, s16, 2
  s_add_u32 s51, s51, s52
  s_lshl_b32 s51, s51, 7
  s_add_u32 s24, s51, 12582912
  s_add_u32 s51, s49, s19
  s_add_u32 s51, s51, s52
  s_lshl_b32 s51, s51, 7
  s_lshl_b32 s52, s17, 3
  s_add_u32 s51, s51, s52
  s_add_u32 s25, s51, 12582912
  s_lshl_b32 s51, s17, 2
  s_add_u32 s51, s51, s49
  s_add_u32 s51, s51, s47
  s_add_u32 s48, s48, s19
  s_lshl_b32 s52, s51, 16
  s_lshl_b32 s49, s48, 11
  s_add_u32 s52, s52, s49
  s_add_u32 s26, s52, 8388608
  s_lshl_b32 s51, s51, 1
  s_lshr_b32 s52, s16, 1
  s_and_b32 s52, s52, 1
  s_add_u32 s51, s51, s52
  s_lshl_b32 s51, s51, 4
  s_and_b32 s52, s16, 12
  s_add_u32 s51, s51, s52
  s_and_b32 s52, s48, 3
  s_add_u32 s51, s51, s52
  s_lshl_b32 s51, s51, 3
  s_add_u32 s27, s51, 13107200
  s_lshl_b32 s51, s45, 2
  s_add_u32 s51, s51, s50
  s_lshl_b32 s52, s51, 1
  s_add_u32 s52, s52, s47
  s_lshl_b32 s52, s52, 7
  s_add_u32 s28, s52, 13107200
  s_lshl_b32 s51, s51, 16
  s_lshl_b32 s52, s47, 13
  s_add_u32 s51, s51, s52
  s_add_u32 s29, s51, 8388608
  v_lshlrev_b32 v3, 4, v0
  v_lshrrev_b32 v164, 3, v0
  v_lshrrev_b32 v165, 2, v0
  v_lshrrev_b32 v166, 4, v0
  v_xor_b32 v168, v165, v166
  v_and_b32 v168, 1, v168
  v_lshlrev_b32 v165, 6, v168
  v_and_b32 v166, 3, v0
  v_lshl_add_u32 v165, v166, 4, v165
  s_lshl_b32 s47, s18, 5
  v_add_u32 v164, s47, v164
  v_lshl_add_u32 v164, v164, 11, v165
  v_add_u32 v165, 15360, v164
  v_add_u32 v166, 30720, v164
  v_add_u32 v167, 46080, v164
  v_mov_b32 v160, v3
  v_mov_b32 v161, v3
  v_mov_b32 v162, v3
  v_mov_b32 v163, v3
  v_cmp_eq_u32 vcc, 0, v168
  v_mov_b32 v169, 0x3f803f80
  s_lshl_b32 s47, s19, 14
  v_add_u32 v173, s47, v3
  v_cndmask_b32 v168, 0, v169, vcc
  s_and_b32 s47, s18, 3
  s_lshl_b32 s47, s47, 11
  s_add_u32 s47, s47, 65536
  v_add_u32 v172, s47, v3
  v_mov_b32 v178, 73728
  s_lshr_b32 s47, s2, 3
  s_lshl_b32 s47, s47, 3
  s_add_u32 s47, s47, s18
  s_lshl_b32 s47, s47, 13
  v_lshlrev_b32 v179, 7, v0
  v_add_u32 v179, s47, v179
  s_lshr_b32 s94, s18, 1
  s_add_u32 s94, s94, 6
  v_mov_b32 v169, v168
  v_mov_b32 v170, v168
  v_mov_b32 v171, v168
  v_and_b32 v175, 4, v0
  v_cmp_eq_u32 vcc, 0, v175
  v_mov_b32 v170, 0x3f803f80
  v_and_b32 v175, 1, v0
  v_cndmask_b32 v168, 0, v170, vcc
  v_cndmask_b32 v169, 0, v170, vcc
  v_cmp_eq_u32 vcc, 0, v175
  v_xor_b32 v170, v170, v168
  v_mov_b32 v175, 0x44444444
  v_mov_b32 v171, 0xeeeeeeee
  v_cndmask_b32 v175, v171, v175, vcc
  v_mov_b32 v171, v170
  s_lshl_b32 s47, s16, 1
  s_add_u32 s47, s47, s19
  s_lshl_b32 s48, s17, 2
  s_lshl_b32 s49, s44, 1
  s_add_u32 s48, s48, s49
  s_lshl_b32 s92, s47, 18
  s_lshl_b32 s51, s48, 12
  s_add_u32 s92, s92, s51
  s_add_u32 s93, s92, 4096
  s_lshl_b32 s47, s19, 14
  s_lshl_b32 s48, s44, 13
  s_add_u32 s47, s47, s48
  v_add_u32 v176, s47, v3
  v_mov_b32 v177, v172
  s_mov_b32 s50, 0
  s_mov_b32 s51, 0
  s_barrier
  ds_read_b128 v[16:19], v4 offset:0
  ds_read_b64_tr_b16 v[32:33], v6 offset:0
  ds_read_b64_tr_b16 v[34:35], v6 offset:512
  ds_read_b128 v[20:23], v4 offset:2048
  ds_read_b128 v[24:27], v4 offset:4096
  ds_read_b128 v[28:31], v4 offset:6144
  ds_read_b64_tr_b16 v[36:37], v7 offset:0
  ds_read_b64_tr_b16 v[38:39], v7 offset:512
  ds_read_b64_tr_b16 v[40:41], v6 offset:2048
  ds_read_b64_tr_b16 v[42:43], v6 offset:2560
  ds_read_b64_tr_b16 v[44:45], v7 offset:2048
  ds_read_b64_tr_b16 v[46:47], v7 offset:2560
  ds_read_b64_tr_b16 v[48:49], v6 offset:4096
  ds_read_b64_tr_b16 v[50:51], v6 offset:4608
  ds_read_b64_tr_b16 v[52:53], v7 offset:4096
  ds_read_b64_tr_b16 v[54:55], v7 offset:4608
  s_waitcnt lgkmcnt(0)
P1_LOOP:
  v_mfma_f32_16x16x32_bf16 v[64:67], v[32:35], v[16:19], v[64:67]
  ds_read_b128 v[210:213], v5 offset:0
  v_mfma_f32_16x16x32_bf16 v[68:71], v[32:35], v[20:23], v[68:71]
  ds_read_b64_tr_b16 v[226:227], v6 offset:12288
  v_mfma_f32_16x16x32_bf16 v[80:83], v[32:35], v[24:27], v[80:83]
  ds_read_b64_tr_b16 v[228:229], v6 offset:12800
  v_mfma_f32_16x16x32_bf16 v[84:87], v[32:35], v[28:31], v[84:87]
  ds_read_b128 v[214:217], v5 offset:2048
  v_mfma_f32_16x16x32_bf16 v[72:75], v[36:39], v[16:19], v[72:75]
  ds_read_b128 v[218:221], v5 offset:4096
  v_mfma_f32_16x16x32_bf16 v[76:79], v[36:39], v[20:23], v[76:79]
  ds_read_b128 v[222:225], v5 offset:6144
  v_mfma_f32_16x16x32_bf16 v[88:91], v[36:39], v[24:27], v[88:91]
  ds_read_b64_tr_b16 v[230:231], v7 offset:12288
  v_mfma_f32_16x16x32_bf16 v[92:95], v[36:39], v[28:31], v[92:95]
  ds_read_b64_tr_b16 v[232:233], v7 offset:12800
  v_mfma_f32_16x16x32_bf16 v[96:99], v[40:43], v[16:19], v[96:99]
  ds_read_b64_tr_b16 v[234:235], v6 offset:14336
  v_mfma_f32_16x16x32_bf16 v[100:103], v[40:43], v[20:23], v[100:103]
  ds_read_b64_tr_b16 v[236:237], v6 offset:14848
  v_mfma_f32_16x16x32_bf16 v[112:115], v[40:43], v[24:27], v[112:115]
  ds_read_b64_tr_b16 v[238:239], v7 offset:14336
  s_add_u32 s51, s51, 1
  v_mfma_f32_16x16x32_bf16 v[116:119], v[40:43], v[28:31], v[116:119]
  ds_read_b64_tr_b16 v[240:241], v7 offset:14848
  s_and_b32 s51, s51, 3
  v_mfma_f32_16x16x32_bf16 v[104:107], v[44:47], v[16:19], v[104:107]
  ds_read_b64_tr_b16 v[242:243], v6 offset:16384
  s_mov_b32 s52, 40960
  v_mfma_f32_16x16x32_bf16 v[108:111], v[44:47], v[20:23], v[108:111]
  ds_read_b64_tr_b16 v[244:245], v6 offset:16896
  s_cselect_b32 s52, s52, 4294844416
  v_mfma_f32_16x16x32_bf16 v[120:123], v[44:47], v[24:27], v[120:123]
  ds_read_b64_tr_b16 v[246:247], v7 offset:16384
  v_mfma_f32_16x16x32_bf16 v[124:127], v[44:47], v[28:31], v[124:127]
  ds_read_b64_tr_b16 v[248:249], v7 offset:16896
  v_mfma_f32_16x16x32_bf16 v[128:131], v[16:19], v[48:51], v[128:131]
  v_add_u32 v4, s52, v4
  v_mfma_f32_16x16x32_bf16 v[136:139], v[20:23], v[48:51], v[136:139]
  s_cmp_eq_u32 s50, s100
  v_add_u32 v5, s52, v5
  v_mfma_f32_16x16x32_bf16 v[144:147], v[24:27], v[48:51], v[144:147]
  s_cbranch_scc1 P1_J0_0
P1_JB0_0:
  v_mfma_f32_16x16x32_bf16 v[152:155], v[28:31], v[48:51], v[152:155]
  s_cmp_eq_u32 s50, s101
  v_add_u32 v6, s52, v6
  v_mfma_f32_16x16x32_bf16 v[132:135], v[16:19], v[52:55], v[132:135]
  s_cbranch_scc1 P1_J1_0
P1_JB1_0:
  v_mfma_f32_16x16x32_bf16 v[140:143], v[20:23], v[52:55], v[140:143]
  v_add_u32 v7, s52, v7
  v_mfma_f32_16x16x32_bf16 v[148:151], v[24:27], v[52:55], v[148:151]
  v_mfma_f32_16x16x32_bf16 v[156:159], v[28:31], v[52:55], v[156:159]
  s_cmp_eq_u32 s50, 15
  s_waitcnt lgkmcnt(0)
  s_cbranch_scc1 P1_LAST
  v_mfma_f32_16x16x32_bf16 v[64:67], v[226:229], v[210:213], v[64:67]
  s_barrier
  v_mfma_f32_16x16x32_bf16 v[68:71], v[226:229], v[214:217], v[68:71]
  ds_read_b128 v[16:19], v4 offset:0
  v_mfma_f32_16x16x32_bf16 v[80:83], v[226:229], v[218:221], v[80:83]
  ds_read_b64_tr_b16 v[32:33], v6 offset:0
  v_mfma_f32_16x16x32_bf16 v[84:87], v[226:229], v[222:225], v[84:87]
  ds_read_b64_tr_b16 v[34:35], v6 offset:512
  v_mfma_f32_16x16x32_bf16 v[72:75], v[230:233], v[210:213], v[72:75]
  ds_read_b128 v[20:23], v4 offset:2048
  v_mfma_f32_16x16x32_bf16 v[76:79], v[230:233], v[214:217], v[76:79]
  ds_read_b128 v[24:27], v4 offset:4096
  v_mfma_f32_16x16x32_bf16 v[88:91], v[230:233], v[218:221], v[88:91]
  ds_read_b128 v[28:31], v4 offset:6144
  v_mfma_f32_16x16x32_bf16 v[92:95], v[230:233], v[222:225], v[92:95]
  ds_read_b64_tr_b16 v[36:37], v7 offset:0
  v_mfma_f32_16x16x32_bf16 v[96:99], v[234:237], v[210:213], v[96:99]
  ds_read_b64_tr_b16 v[38:39], v7 offset:512
  v_mfma_f32_16x16x32_bf16 v[100:103], v[234:237], v[214:217], v[100:103]
  ds_read_b64_tr_b16 v[40:41], v6 offset:2048
  v_mfma_f32_16x16x32_bf16 v[112:115], v[234:237], v[218:221], v[112:115]
  ds_read_b64_tr_b16 v[42:43], v6 offset:2560
  v_mfma_f32_16x16x32_bf16 v[116:119], v[234:237], v[222:225], v[116:119]
  ds_read_b64_tr_b16 v[44:45], v7 offset:2048
  v_mfma_f32_16x16x32_bf16 v[104:107], v[238:241], v[210:213], v[104:107]
  ds_read_b64_tr_b16 v[46:47], v7 offset:2560
  v_mfma_f32_16x16x32_bf16 v[108:111], v[238:241], v[214:217], v[108:111]
  ds_read_b64_tr_b16 v[48:49], v6 offset:4096
  v_mfma_f32_16x16x32_bf16 v[120:123], v[238:241], v[218:221], v[120:123]
  ds_read_b64_tr_b16 v[50:51], v6 offset:4608
  v_mfma_f32_16x16x32_bf16 v[124:127], v[238:241], v[222:225], v[124:127]
  ds_read_b64_tr_b16 v[52:53], v7 offset:4096
  v_mfma_f32_16x16x32_bf16 v[128:131], v[210:213], v[242:245], v[128:131]
  ds_read_b64_tr_b16 v[54:55], v7 offset:4608
  v_mfma_f32_16x16x32_bf16 v[136:139], v[214:217], v[242:245], v[136:139]
  v_mfma_f32_16x16x32_bf16 v[144:147], v[218:221], v[242:245], v[144:147]
  v_mfma_f32_16x16x32_bf16 v[152:155], v[222:225], v[242:245], v[152:155]
  v_mfma_f32_16x16x32_bf16 v[132:135], v[210:213], v[246:249], v[132:135]
  v_mfma_f32_16x16x32_bf16 v[140:143], v[214:217], v[246:249], v[140:143]
  s_add_u32 s50, s50, 1
  v_mfma_f32_16x16x32_bf16 v[148:151], v[218:221], v[246:249], v[148:151]
  s_cmp_lt_u32 s50, 16
  v_mfma_f32_16x16x32_bf16 v[156:159], v[222:225], v[246:249], v[156:159]
  s_waitcnt lgkmcnt(0)
  s_cbranch_scc1 P1_LOOP
P1_LAST:
  v_mfma_f32_16x16x32_bf16 v[96:99], v[234:237], v[210:213], v[96:99]
  s_barrier
  v_mfma_f32_16x16x32_bf16 v[100:103], v[234:237], v[214:217], v[100:103]
  v_and_b32 v12, 0x33, v0
  v_and_b32 v14, 4, v0
  v_and_b32 v15, 8, v0
  v_mfma_f32_16x16x32_bf16 v[104:107], v[238:241], v[210:213], v[104:107]
  v_lshl_or_b32 v12, v14, 1, v12
  v_lshrrev_b32 v15, 1, v15
  v_mfma_f32_16x16x32_bf16 v[108:111], v[238:241], v[214:217], v[108:111]
  v_or_b32 v12, v12, v15
  v_lshlrev_b32 v12, 4, v12
  v_mfma_f32_16x16x32_bf16 v[128:131], v[210:213], v[242:245], v[128:131]
  v_sub_u32 v13, v176, v3
  v_add_u32 v13, v13, v12
  v_mfma_f32_16x16x32_bf16 v[136:139], v[214:217], v[242:245], v[136:139]
  v_mfma_f32_16x16x32_bf16 v[132:135], v[210:213], v[246:249], v[132:135]
  v_cvt_pk_bf16_f32 v16, v96, v97
  v_cvt_pk_bf16_f32 v17, v98, v99
  v_cvt_pk_bf16_f32 v18, v100, v101
  v_mfma_f32_16x16x32_bf16 v[140:143], v[214:217], v[246:249], v[140:143]
  v_cvt_pk_bf16_f32 v19, v102, v103
  v_cvt_pk_bf16_f32 v20, v104, v105
  v_cvt_pk_bf16_f32 v21, v106, v107
  v_mfma_f32_16x16x32_bf16 v[112:115], v[234:237], v[218:221], v[112:115]
  v_cvt_pk_bf16_f32 v22, v108, v109
  v_cvt_pk_bf16_f32 v23, v110, v111
  v_cvt_pk_bf16_f32 v24, v128, v129
  v_mfma_f32_16x16x32_bf16 v[116:119], v[234:237], v[222:225], v[116:119]
  v_permlane16_swap_b32 v16, v18
  v_permlane16_swap_b32 v17, v19
  v_permlane16_swap_b32 v20, v22
  v_mfma_f32_16x16x32_bf16 v[120:123], v[238:241], v[218:221], v[120:123]
  v_permlane16_swap_b32 v21, v23
  v_cvt_pk_bf16_f32 v25, v130, v131
  v_cvt_pk_bf16_f32 v26, v132, v133
  v_mfma_f32_16x16x32_bf16 v[124:127], v[238:241], v[222:225], v[124:127]
  v_cvt_pk_bf16_f32 v27, v134, v135
  v_cvt_pk_bf16_f32 v28, v136, v137
  v_cvt_pk_bf16_f32 v29, v138, v139
  v_mfma_f32_16x16x32_bf16 v[144:147], v[218:221], v[242:245], v[144:147]
  v_cvt_pk_bf16_f32 v30, v140, v141
  v_cvt_pk_bf16_f32 v31, v142, v143
  buffer_store_dwordx4 v[16:19], v12, s[20:23], s92 offen offset:0 sc1
  v_mfma_f32_16x16x32_bf16 v[152:155], v[222:225], v[242:245], v[152:155]
  buffer_store_dwordx4 v[20:23], v12, s[20:23], s92 offen offset:1024 sc1
  v_cvt_pk_bf16_f32 v32, v112, v113
  v_cvt_pk_bf16_f32 v33, v114, v115
  v_mfma_f32_16x16x32_bf16 v[148:151], v[218:221], v[246:249], v[148:151]
  v_permlane16_swap_b32 v24, v26
  v_permlane16_swap_b32 v25, v27
  v_permlane16_swap_b32 v28, v30
  v_mfma_f32_16x16x32_bf16 v[156:159], v[222:225], v[246:249], v[156:159]
  v_permlane16_swap_b32 v29, v31
  v_cvt_pk_bf16_f32 v34, v116, v117
  v_cvt_pk_bf16_f32 v35, v118, v119
  v_mfma_f32_16x16x32_bf16 v[80:83], v[226:229], v[218:221], v[80:83]
  buffer_store_dwordx4 v[24:27], v3, s[20:23], s92 offen offset:2048 sc1
  buffer_store_dwordx4 v[28:31], v3, s[20:23], s92 offen offset:3072 sc1
  v_cvt_pk_bf16_f32 v36, v120, v121
  v_cvt_pk_bf16_f32 v37, v122, v123
  v_mfma_f32_16x16x32_bf16 v[84:87], v[226:229], v[222:225], v[84:87]
  v_cvt_pk_bf16_f32 v38, v124, v125
  v_cvt_pk_bf16_f32 v39, v126, v127
  v_cvt_pk_bf16_f32 v40, v144, v145
  v_mfma_f32_16x16x32_bf16 v[88:91], v[230:233], v[218:221], v[88:91]
  v_cvt_pk_bf16_f32 v41, v146, v147
  v_cvt_pk_bf16_f32 v42, v148, v149
  v_cvt_pk_bf16_f32 v43, v150, v151
  v_mfma_f32_16x16x32_bf16 v[92:95], v[230:233], v[222:225], v[92:95]
  v_permlane16_swap_b32 v32, v34
  v_permlane16_swap_b32 v33, v35
  v_permlane16_swap_b32 v36, v38
  v_mfma_f32_16x16x32_bf16 v[64:67], v[226:229], v[210:213], v[64:67]
  v_permlane16_swap_b32 v37, v39
  v_cvt_pk_bf16_f32 v44, v152, v153
  v_cvt_pk_bf16_f32 v45, v154, v155
  v_mfma_f32_16x16x32_bf16 v[68:71], v[226:229], v[214:217], v[68:71]
  v_cvt_pk_bf16_f32 v46, v156, v157
  v_cvt_pk_bf16_f32 v47, v158, v159
  buffer_store_dwordx4 v[32:35], v12, s[20:23], s93 offen offset:0 sc1
  v_mfma_f32_16x16x32_bf16 v[72:75], v[230:233], v[210:213], v[72:75]
  buffer_store_dwordx4 v[36:39], v12, s[20:23], s93 offen offset:1024 sc1
  v_permlane16_swap_b32 v40, v42
  v_permlane16_swap_b32 v41, v43
  v_mfma_f32_16x16x32_bf16 v[76:79], v[230:233], v[214:217], v[76:79]
  v_permlane16_swap_b32 v44, v46
  v_permlane16_swap_b32 v45, v47
  s_nop 0
  buffer_store_dwordx4 v[40:43], v3, s[20:23], s93 offen offset:2048 sc1
  buffer_store_dwordx4 v[44:47], v3, s[20:23], s93 offen offset:3072 sc1
  s_add_u32 s50, s50, 1
  s_setprio 0
  ds_write_b128 v13, v[16:19] offset:0
  s_mov_b32 s47, 0x3e8293ee
  v_mul_f32 v80, s47, v80
  v_mul_f32 v81, s47, v81
  ds_write_b128 v13, v[20:23] offset:1024
  v_mul_f32 v82, s47, v82
  v_mul_f32 v83, s47, v83
  ds_write_b128 v176, v[24:27] offset:2048
  v_mul_f32 v84, s47, v84
  v_mul_f32 v85, s47, v85
  ds_write_b128 v176, v[28:31] offset:3072
  v_mul_f32 v86, s47, v86
  v_mul_f32 v87, s47, v87
  ds_write_b128 v13, v[32:35] offset:4096
  v_mul_f32 v88, s47, v88
  v_mul_f32 v89, s47, v89
  ds_write_b128 v13, v[36:39] offset:5120
  v_mul_f32 v90, s47, v90
  v_mul_f32 v91, s47, v91
  ds_write_b128 v176, v[40:43] offset:6144
  v_mul_f32 v92, s47, v92
  v_mul_f32 v93, s47, v93
  ds_write_b128 v176, v[44:47] offset:7168
  v_mul_f32 v94, s47, v94
  v_mul_f32 v95, s47, v95
  v_cvt_pk_bf16_f32 v48, v80, v81
  v_cvt_pk_bf16_f32 v49, v82, v83
  v_cvt_pk_bf16_f32 v50, v84, v85
  v_cvt_pk_bf16_f32 v51, v86, v87
  v_cvt_pk_bf16_f32 v52, v88, v89
  v_cvt_pk_bf16_f32 v53, v90, v91
  v_cvt_pk_bf16_f32 v54, v92, v93
  v_cvt_pk_bf16_f32 v55, v94, v95
  v_mul_f32 v64, s47, v64
  v_mul_f32 v65, s47, v65
  v_permlane16_swap_b32 v48, v50
  v_permlane16_swap_b32 v49, v51
  v_permlane16_swap_b32 v52, v54
  v_permlane16_swap_b32 v53, v55
  v_mul_f32 v66, s47, v66
  v_mul_f32 v67, s47, v67
  ds_write_b128 v177, v[48:51]
  v_mul_f32 v68, s47, v68
  v_mul_f32 v69, s47, v69
  v_mul_f32 v70, s47, v70
  v_mul_f32 v71, s47, v71
  ds_write_b128 v177, v[52:55] offset:1024
  v_mul_f32 v72, s47, v72
  v_mul_f32 v73, s47, v73
  v_mul_f32 v74, s47, v74
  v_mul_f32 v75, s47, v75
  v_mul_f32 v76, s47, v76
  v_mul_f32 v77, s47, v77
  v_mul_f32 v78, s47, v78
  v_mul_f32 v79, s47, v79
  v_cvt_pk_bf16_f32 v4, v64, v65
  v_cvt_pk_bf16_f32 v5, v66, v67
  v_cvt_pk_bf16_f32 v6, v68, v69
  v_cvt_pk_bf16_f32 v7, v70, v71
  v_cvt_pk_bf16_f32 v8, v72, v73
  v_cvt_pk_bf16_f32 v9, v74, v75
  v_cvt_pk_bf16_f32 v10, v76, v77
  v_cvt_pk_bf16_f32 v11, v78, v79
  s_nop 0
  v_permlane16_swap_b32 v4, v6
  v_permlane16_swap_b32 v5, v7
  v_permlane16_swap_b32 v8, v10
  v_permlane16_swap_b32 v9, v11
P2_START:
  v_cmp_gt_u32 vcc, 16, v0
  v_lshlrev_b32 v121, 3, v0
  v_lshlrev_b32 v127, 3, v0
  v_mov_b32 v120, 0x40000000
  v_cndmask_b32 v121, v120, v121, vcc
  v_cndmask_b32 v127, v120, v127, vcc
  s_waitcnt lgkmcnt(0)
  s_barrier
  ds_read_b64 v[122:123], v178
  s_cmp_lt_u32 s18, 4
  s_cbranch_scc1 P2_NOQ
  ds_read_b128 v[4:7], v172
  ds_read_b128 v[8:11], v172 offset:1024
P2_NOQ:
  ds_read_b128 v[72:75], v173
  ds_read_b128 v[76:79], v173 offset:1024
  v_mov_b32 v96, 0
  v_mov_b32 v97, 0
  v_mov_b32 v98, 0
  v_mov_b32 v99, 0
  v_mov_b32 v100, 0
  v_mov_b32 v101, 0
  v_mov_b32 v102, 0
  v_mov_b32 v103, 0
  v_mov_b32 v104, 0
  v_mov_b32 v105, 0
  v_mov_b32 v106, 0
  v_mov_b32 v107, 0
  v_mov_b32 v108, 0
  v_mov_b32 v109, 0
  v_mov_b32 v110, 0
  v_mov_b32 v111, 0
  v_mov_b32 v88, 0
  v_mov_b32 v89, 0
  v_mov_b32 v90, 0
  v_mov_b32 v91, 0
  s_waitcnt lgkmcnt(0)
  v_readfirstlane_b32 s64, v122
  v_readfirstlane_b32 s65, v123
  v_mfma_f32_32x32x16_bf16 v[32:47], v[72:75], v[4:7], 0
  v_mfma_f32_32x32x16_bf16 v[32:47], v[76:79], v[8:11], v[32:47]
  s_cmp_ge_u32 s18, 4
  s_cbranch_scc1 P2_NOF1
  v_mov_b32 v124, 0
  s_mov_b64 s[68:69], exec
  s_waitcnt vmcnt(0)
  s_mov_b64 exec, 1
  buffer_atomic_swap_x2 v[122:123], v124, s[20:23], s25 offen sc1
  s_mov_b64 exec, s[68:69]
P2_NOF1:
  v_mov_b32 v64, 0
  v_mov_b32 v65, 0
  v_mov_b32 v66, 0
  v_mov_b32 v67, 0
  v_mov_b32 v68, 0
  v_mov_b32 v69, 0
  v_mov_b32 v70, 0
  v_mov_b32 v71, 0
  v_mov_b32 v80, 0
  v_mov_b32 v81, 0
  v_mov_b32 v82, 0
  v_mov_b32 v83, 0
  v_mov_b32 v84, 0
  v_mov_b32 v85, 0
  v_mov_b32 v86, 0
  v_mov_b32 v87, 0
  v_max3_f32 v16, v32, v33, v34
  v_max3_f32 v16, v16, v35, v36
  v_max3_f32 v16, v16, v37, v38
  v_max3_f32 v16, v16, v39, v40
  v_max3_f32 v16, v16, v41, v42
  v_max3_f32 v16, v16, v43, v44
  v_max3_f32 v16, v16, v45, v46
  v_max_f32 v16, v16, v47
  v_mov_b32 v17, v16
  s_nop 1
  v_permlane32_swap_b32 v16, v17
  s_nop 1
  v_max_f32 v16, v16, v17
  v_sub_f32 v16, 0, v16
  v_mov_b32 v17, v16
  v_mov_b32 v18, v16
  v_mov_b32 v19, v16
  v_mov_b32 v20, v16
  v_mov_b32 v21, v16
  v_mov_b32 v22, v16
  v_mov_b32 v23, v16
  v_mov_b32 v24, v16
  v_mov_b32 v25, v16
  v_mov_b32 v26, v16
  v_mov_b32 v27, v16
  v_mov_b32 v28, v16
  v_mov_b32 v29, v16
  v_mov_b32 v30, v16
  v_mov_b32 v31, v16
  s_nop 1
  v_mfma_f32_32x32x16_bf16 v[32:47], v[72:75], v[4:7], v[16:31]
  v_mfma_f32_32x32x16_bf16 v[32:47], v[76:79], v[8:11], v[32:47]
  s_mov_b32 s67, 0
  s_mov_b32 s66, 0
  s_setprio 3
  s_nop 10
  v_mfma_f32_32x32x16_bf16 v[96:111], v[80:83], v[64:67], v[96:111]
  s_nop 0
  v_exp_f32 v32, v32
  ds_read_b128 v[72:75], v173 offset:4096
  v_exp_f32 v33, v33
  ds_read_b128 v[76:79], v173 offset:5120
  v_exp_f32 v34, v34
  v_exp_f32 v35, v35
  v_exp_f32 v36, v36
  v_exp_f32 v37, v37
  v_mfma_f32_32x32x16_bf16 v[96:111], v[84:87], v[68:71], v[96:111]
  ds_read_b128 v[80:83], v173 offset:2048
  v_exp_f32 v38, v38
  ds_read_b128 v[84:87], v173 offset:3072
  v_exp_f32 v39, v39
  v_exp_f32 v40, v40
  v_exp_f32 v41, v41
  v_smfmac_f32_16x16x64_bf16 v[88:91], v[168:171], v[64:71], v175
  v_exp_f32 v42, v42
  v_exp_f32 v43, v43
  s_waitcnt lgkmcnt(2)
  v_mfma_f32_32x32x16_bf16 v[48:63], v[72:75], v[4:7], v[16:31]
  v_exp_f32 v44, v44
  v_exp_f32 v45, v45
  v_exp_f32 v46, v46
  v_exp_f32 v47, v47
  v_mfma_f32_32x32x16_bf16 v[48:63], v[76:79], v[8:11], v[48:63]
  s_setprio 2
  s_waitcnt lgkmcnt(0)
  v_cvt_pk_bf16_f32 v64, v32, v33
  v_cvt_pk_bf16_f32 v65, v34, v35
  v_cvt_pk_bf16_f32 v66, v36, v37
  v_cvt_pk_bf16_f32 v67, v38, v39
  v_cvt_pk_bf16_f32 v68, v40, v41
  v_cvt_pk_bf16_f32 v69, v42, v43
  v_cvt_pk_bf16_f32 v70, v44, v45
  v_cvt_pk_bf16_f32 v71, v46, v47
  v_mfma_f32_32x32x16_bf16 v[96:111], v[80:83], v[64:67], v[96:111]
  s_nop 0
  v_exp_f32 v48, v48
  ds_read_b128 v[72:75], v173 offset:8192
  v_exp_f32 v49, v49
  ds_read_b128 v[76:79], v173 offset:9216
  v_exp_f32 v50, v50
  v_exp_f32 v51, v51
  v_exp_f32 v52, v52
  v_exp_f32 v53, v53
  v_mfma_f32_32x32x16_bf16 v[96:111], v[84:87], v[68:71], v[96:111]
  ds_read_b128 v[80:83], v173 offset:6144
  v_exp_f32 v54, v54
  ds_read_b128 v[84:87], v173 offset:7168
  v_exp_f32 v55, v55
  v_exp_f32 v56, v56
  v_exp_f32 v57, v57
  v_smfmac_f32_16x16x64_bf16 v[88:91], v[168:171], v[64:71], v175
  v_exp_f32 v58, v58
  v_exp_f32 v59, v59
  s_waitcnt lgkmcnt(2)
  v_mfma_f32_32x32x16_bf16 v[32:47], v[72:75], v[4:7], v[16:31]
  v_exp_f32 v60, v60
  buffer_load_dwordx2 v[122:123], v121, s[20:23], s24 offen sc1
  v_exp_f32 v61, v61
  v_exp_f32 v62, v62
  v_exp_f32 v63, v63
  v_mfma_f32_32x32x16_bf16 v[32:47], v[76:79], v[8:11], v[32:47]
  s_setprio 1
  s_waitcnt lgkmcnt(0)
  v_cvt_pk_bf16_f32 v64, v48, v49
  v_cvt_pk_bf16_f32 v65, v50, v51
  v_cvt_pk_bf16_f32 v66, v52, v53
  v_cvt_pk_bf16_f32 v67, v54, v55
  v_cvt_pk_bf16_f32 v68, v56, v57
  v_cvt_pk_bf16_f32 v69, v58, v59
  v_cvt_pk_bf16_f32 v70, v60, v61
  v_cvt_pk_bf16_f32 v71, v62, v63
P2_CHK0:
  s_waitcnt vmcnt(0)
  v_cmp_eq_u32 vcc, s64, v122
  v_cmp_eq_u32 s[68:69], s65, v123
  s_nop 1
  s_and_b32 s47, vcc_lo, s68
  s_and_b32 s47, s47, 0xffff
  s_or_b32 s63, s63, s47
  s_and_b32 s47, s57, s63
  s_bcnt1_i32_b32 s48, s47
  s_cmp_ge_u32 s48, 2
  s_cbranch_scc1 P2_GO0
  s_add_u32 s66, s66, 1
  s_cmp_ge_u32 s66, 131072
  s_cbranch_scc1 P2_TMO0
  buffer_load_dwordx2 v[122:123], v121, s[20:23], s24 offen sc1
  s_branch P2_CHK0
P2_TMO0:
  s_mov_b32 s63, 0xffff
  s_mov_b32 s47, s57
P2_GO0:
  s_ff1_i32_b32 s48, s47
  s_bitset0_b32 s57, s48
  s_bitset0_b32 s47, s48
  s_mul_i32 s60, s48, s58
  s_add_u32 m0, s61, 0x8000
  s_add_u32 s60, s60, s59
  s_ff1_i32_b32 s48, s47
  buffer_load_dwordx4 v160, s[40:43], s60 offen offset:0 sc1 lds
  buffer_load_dwordx4 v161, s[40:43], s60 offen offset:1024 sc1 lds
  buffer_load_dwordx4 v162, s[40:43], s60 offen offset:2048 sc1 lds
  buffer_load_dwordx4 v163, s[40:43], s60 offen offset:3072 sc1 lds
  s_bitset0_b32 s57, s48
  s_mul_i32 s60, s48, s58
  s_add_u32 m0, s61, 0x18000
  s_add_u32 s60, s60, s59
  buffer_load_dwordx4 v160, s[40:43], s60 offen offset:0 sc1 lds
  buffer_load_dwordx4 v161, s[40:43], s60 offen offset:1024 sc1 lds
  buffer_load_dwordx4 v162, s[40:43], s60 offen offset:2048 sc1 lds
  s_branch P2_U2
P2_SW:
  s_mov_b32 s40, s36
  s_mov_b32 s41, s37
  s_mov_b32 s42, s38
  s_mov_b32 s43, s39
  s_mov_b32 s59, 0
  s_mov_b32 s57, 14
  s_mov_b32 s63, 0xffff
  s_mov_b32 s67, 0
  s_mov_b32 s58, 524288
  v_mov_b32 v160, v164
  v_mov_b32 v161, v165
  v_mov_b32 v162, v166
  v_mov_b32 v163, v167
  s_branch P2_SWBACK
P2_WO0:
  s_mov_b32 s49, m0
  s_add_u32 m0, s61, 131072
  s_nop 0
  buffer_load_dwordx4 v164, s[36:39], 0 offen lds
  buffer_load_dwordx4 v165, s[36:39], 0 offen offset:1024 lds
  buffer_load_dwordx4 v166, s[36:39], 0 offen offset:2048 lds
  buffer_load_dwordx4 v167, s[36:39], 0 offen offset:3072 lds
  s_mov_b32 m0, s49
  s_branch P2_WO0B
P2_PFW:
  global_load_dword v126, v179, s[8:9]
  s_branch P2_PFWB
P2_PLISS:
  buffer_load_dwordx2 v[122:123], v121, s[20:23], s24 offen sc1
  s_mov_b32 s67, 1
  s_branch P2_PLISSB
P2_PLCHK:
  s_waitcnt vmcnt(2)
  v_cmp_eq_u32 vcc, s64, v122
  v_cmp_eq_u32 s[68:69], s65, v123
  s_nop 1
  s_and_b32 s47, vcc_lo, s68
  s_and_b32 s47, s47, 0xffff
  s_or_b32 s63, s63, s47
  s_mov_b32 s67, 0
  s_branch P2_PLCHKB
P2_POLL:
  buffer_load_dwordx2 v[122:123], v121, s[20:23], s24 offen sc1
  s_waitcnt vmcnt(0)
  v_cmp_eq_u32 vcc, s64, v122
  v_cmp_eq_u32 s[68:69], s65, v123
  s_nop 1
  s_and_b32 s47, vcc_lo, s68
  s_and_b32 s47, s47, 0xffff
  s_or_b32 s63, s63, s47
  s_add_u32 s66, s66, 1
  s_cmp_ge_u32 s66, 131072
  s_cselect_b32 s63, 0xffff, s63
  s_and_b32 s47, s57, s63
  s_cbranch_scc0 P2_POLL
  s_branch P2_POLLB
P2_LOOP:
  v_mfma_f32_32x32x16_bf16 v[96:111], v[80:83], v[64:67], v[96:111]
  buffer_load_dwordx4 v161, s[40:43], s60 offen offset:1024 sc1 lds
  v_exp_f32 v32, v32
  ds_read_b128 v[72:75], v173 offset:4096
  v_exp_f32 v33, v33
  ds_read_b128 v[76:79], v173 offset:5120
  v_exp_f32 v34, v34
  s_cmp_lg_u32 s63, 0xffff
  v_exp_f32 v35, v35
  s_cbranch_scc1 P2_PLISS
P2_PLISSB:
  v_exp_f32 v36, v36
  v_exp_f32 v37, v37
  v_mfma_f32_32x32x16_bf16 v[96:111], v[84:87], v[68:71], v[96:111]
  ds_read_b128 v[80:83], v173 offset:2048
  v_exp_f32 v38, v38
  ds_read_b128 v[84:87], v173 offset:3072
  v_exp_f32 v39, v39
  v_exp_f32 v40, v40
  v_exp_f32 v41, v41
  v_smfmac_f32_16x16x64_bf16 v[88:91], v[168:171], v[64:71], v175
  v_exp_f32 v42, v42
  v_exp_f32 v43, v43
  s_waitcnt lgkmcnt(2)
  v_mfma_f32_32x32x16_bf16 v[48:63], v[72:75], v[4:7], v[16:31]
  v_exp_f32 v44, v44
  v_exp_f32 v45, v45
  v_exp_f32 v46, v46
  v_exp_f32 v47, v47
  v_mfma_f32_32x32x16_bf16 v[48:63], v[76:79], v[8:11], v[48:63]
  s_setprio 2
  s_waitcnt lgkmcnt(0)
  v_cvt_pk_bf16_f32 v64, v32, v33
  v_cvt_pk_bf16_f32 v65, v34, v35
  v_cvt_pk_bf16_f32 v66, v36, v37
  v_cvt_pk_bf16_f32 v67, v38, v39
  v_cvt_pk_bf16_f32 v68, v40, v41
  v_cvt_pk_bf16_f32 v69, v42, v43
  v_cvt_pk_bf16_f32 v70, v44, v45
  v_cvt_pk_bf16_f32 v71, v46, v47
  v_mfma_f32_32x32x16_bf16 v[96:111], v[80:83], v[64:67], v[96:111]
  buffer_load_dwordx4 v162, s[40:43], s60 offen offset:2048 sc1 lds
  v_exp_f32 v48, v48
  ds_read_b128 v[72:75], v173 offset:8192
  v_exp_f32 v49, v49
  ds_read_b128 v[76:79], v173 offset:9216
  v_exp_f32 v50, v50
  v_exp_f32 v51, v51
  v_exp_f32 v52, v52
  v_exp_f32 v53, v53
  v_mfma_f32_32x32x16_bf16 v[96:111], v[84:87], v[68:71], v[96:111]
  ds_read_b128 v[80:83], v173 offset:6144
  v_exp_f32 v54, v54
  ds_read_b128 v[84:87], v173 offset:7168
  v_exp_f32 v55, v55
  v_exp_f32 v56, v56
  v_exp_f32 v57, v57
  v_smfmac_f32_16x16x64_bf16 v[88:91], v[168:171], v[64:71], v175
  v_exp_f32 v58, v58
  v_exp_f32 v59, v59
  s_waitcnt lgkmcnt(2)
  v_mfma_f32_32x32x16_bf16 v[32:47], v[72:75], v[4:7], v[16:31]
  v_exp_f32 v60, v60
  v_exp_f32 v61, v61
  v_exp_f32 v62, v62
  v_exp_f32 v63, v63
  v_mfma_f32_32x32x16_bf16 v[32:47], v[76:79], v[8:11], v[32:47]
  s_setprio 1
  s_waitcnt lgkmcnt(0)
  v_cvt_pk_bf16_f32 v64, v48, v49
  v_cvt_pk_bf16_f32 v65, v50, v51
  v_cvt_pk_bf16_f32 v66, v52, v53
  v_cvt_pk_bf16_f32 v67, v54, v55
  v_cvt_pk_bf16_f32 v68, v56, v57
  v_cvt_pk_bf16_f32 v69, v58, v59
  v_cvt_pk_bf16_f32 v70, v60, v61
  v_cvt_pk_bf16_f32 v71, v62, v63
P2_U2:
  v_mfma_f32_32x32x16_bf16 v[96:111], v[80:83], v[64:67], v[96:111]
  buffer_load_dwordx4 v163, s[40:43], s60 offen offset:3072 sc1 lds
  v_exp_f32 v32, v32
  ds_read_b128 v[72:75], v173 offset:12288
  v_exp_f32 v33, v33
  ds_read_b128 v[76:79], v173 offset:13312
  v_exp_f32 v34, v34
  s_cmp_eq_u32 s56, 13
  v_exp_f32 v35, v35
  s_cbranch_scc1 P2_SW
P2_SWBACK:
  s_cmp_lg_u32 s67, 0
  v_exp_f32 v36, v36
  s_cbranch_scc1 P2_PLCHK
P2_PLCHKB:
  v_exp_f32 v37, v37
  s_and_b32 s47, s57, s63
  v_mfma_f32_32x32x16_bf16 v[96:111], v[84:87], v[68:71], v[96:111]
  ds_read_b128 v[80:83], v173 offset:10240
  v_exp_f32 v38, v38
  ds_read_b128 v[84:87], v173 offset:11264
  v_exp_f32 v39, v39
  s_cbranch_scc0 P2_POLL
P2_POLLB:
  v_exp_f32 v40, v40
  s_ff1_i32_b32 s48, s47
  v_exp_f32 v41, v41
  s_bitset0_b32 s57, s48
  v_smfmac_f32_16x16x64_bf16 v[88:91], v[168:171], v[64:71], v175
  s_mul_i32 s60, s48, s58
  v_exp_f32 v42, v42
  s_add_u32 s60, s60, s59
  v_exp_f32 v43, v43
  s_waitcnt lgkmcnt(2)
  v_mfma_f32_32x32x16_bf16 v[48:63], v[72:75], v[4:7], v[16:31]
  v_exp_f32 v44, v44
  s_xor_b32 m0, m0, s62
  v_exp_f32 v45, v45
  s_cmp_eq_u32 s56, s94
  v_exp_f32 v46, v46
  s_cbranch_scc1 P2_PFW
P2_PFWB:
  v_exp_f32 v47, v47
  v_mfma_f32_32x32x16_bf16 v[48:63], v[76:79], v[8:11], v[48:63]
  s_setprio 0
  s_waitcnt lgkmcnt(0)
  v_cvt_pk_bf16_f32 v64, v32, v33
  v_cvt_pk_bf16_f32 v65, v34, v35
  v_cvt_pk_bf16_f32 v66, v36, v37
  v_cvt_pk_bf16_f32 v67, v38, v39
  v_xor_b32 v174, s62, v173
  v_cvt_pk_bf16_f32 v68, v40, v41
  v_cvt_pk_bf16_f32 v69, v42, v43
  v_cvt_pk_bf16_f32 v70, v44, v45
  v_cvt_pk_bf16_f32 v71, v46, v47
  v_mfma_f32_32x32x16_bf16 v[96:111], v[80:83], v[64:67], v[96:111]
  v_exp_f32 v48, v48
  v_exp_f32 v49, v49
  v_exp_f32 v50, v50
  v_exp_f32 v51, v51
  s_waitcnt vmcnt(4)
  s_barrier
  v_exp_f32 v52, v52
  ds_read_b128 v[72:75], v174 offset:0
  v_exp_f32 v53, v53
  ds_read_b128 v[76:79], v174 offset:1024
  v_mfma_f32_32x32x16_bf16 v[96:111], v[84:87], v[68:71], v[96:111]
  ds_read_b128 v[80:83], v173 offset:14336
  v_exp_f32 v54, v54
  ds_read_b128 v[84:87], v173 offset:15360
  s_cmp_eq_u32 s56, 13
  v_exp_f32 v55, v55
  s_cbranch_scc1 P2_WO0
P2_WO0B:
  v_exp_f32 v56, v56
  buffer_load_dwordx4 v160, s[40:43], s60 offen offset:0 sc1 lds
  v_exp_f32 v57, v57
  s_xor_b32 s62, s62, 0x18000
  v_smfmac_f32_16x16x64_bf16 v[88:91], v[168:171], v[64:71], v175
  s_add_u32 s56, s56, 1
  v_exp_f32 v58, v58
  v_exp_f32 v59, v59
  s_waitcnt lgkmcnt(2)
  v_mfma_f32_32x32x16_bf16 v[32:47], v[72:75], v[4:7], v[16:31]
  v_exp_f32 v60, v60
  v_exp_f32 v61, v61
  s_cmp_lt_u32 s56, 16
  v_exp_f32 v62, v62
  v_exp_f32 v63, v63
  v_mfma_f32_32x32x16_bf16 v[32:47], v[76:79], v[8:11], v[32:47]
  s_setprio 3
  s_waitcnt lgkmcnt(0)
  v_cvt_pk_bf16_f32 v64, v48, v49
  v_cvt_pk_bf16_f32 v65, v50, v51
  v_cvt_pk_bf16_f32 v66, v52, v53
  v_cvt_pk_bf16_f32 v67, v54, v55
  v_mov_b32 v173, v174
  v_cvt_pk_bf16_f32 v68, v56, v57
  v_cvt_pk_bf16_f32 v69, v58, v59
  v_cvt_pk_bf16_f32 v70, v60, v61
  v_cvt_pk_bf16_f32 v71, v62, v63
  s_cbranch_scc1 P2_LOOP
  s_setprio 0
  buffer_load_dwordx4 v161, s[40:43], s60 offen offset:1024 sc1 lds
  buffer_load_dwordx4 v162, s[40:43], s60 offen offset:2048 sc1 lds
  buffer_load_dwordx4 v163, s[40:43], s60 offen offset:3072 sc1 lds
  buffer_load_dwordx2 v[124:125], v127, s[20:23], s28 offen sc1
  s_waitcnt lgkmcnt(0)
  s_nop 1
  v_mfma_f32_32x32x16_bf16 v[96:111], v[80:83], v[64:67], v[96:111]
  v_mfma_f32_32x32x16_bf16 v[96:111], v[84:87], v[68:71], v[96:111]
  v_smfmac_f32_16x16x64_bf16 v[88:91], v[168:171], v[64:71], v175
  v_lshrrev_b32 v14, 2, v0
  v_and_b32 v14, 3, v14
  v_lshrrev_b32 v15, 5, v0
  v_lshl_add_u32 v15, v15, 2, v14
  v_lshlrev_b32 v15, 7, v15
  v_lshrrev_b32 v14, 1, v14
  v_lshl_add_u32 v15, v14, 6, v15
  v_lshrrev_b32 v14, 4, v0
  v_and_b32 v14, 1, v14
  v_lshl_add_u32 v15, v14, 5, v15
  v_and_b32 v14, 3, v0
  v_lshl_add_u32 v15, v14, 3, v15
  s_lshr_b32 s49, s18, 2
  s_lshl_b32 s49, s49, 14
  v_add_u32 v15, s49, v15
  s_nop 3
  s_nop 3
  v_add_f32 v88, v88, v89
  s_nop 0
  v_rcp_f32 v89, v88
  s_nop 1
P2_NORM:
  v_mul_f32 v96, v96, v89
  v_mul_f32 v97, v97, v89
  v_mul_f32 v98, v98, v89
  v_mul_f32 v99, v99, v89
  v_mul_f32 v100, v100, v89
  v_mul_f32 v101, v101, v89
  v_mul_f32 v102, v102, v89
  v_mul_f32 v103, v103, v89
  v_mul_f32 v104, v104, v89
  v_mul_f32 v105, v105, v89
  v_mul_f32 v106, v106, v89
  v_mul_f32 v107, v107, v89
  v_mul_f32 v108, v108, v89
  v_mul_f32 v109, v109, v89
  v_mul_f32 v110, v110, v89
  v_mul_f32 v111, v111, v89
  v_cvt_pk_bf16_f32 v64, v96, v97
  v_cvt_pk_bf16_f32 v65, v98, v99
  v_cvt_pk_bf16_f32 v66, v100, v101
  v_cvt_pk_bf16_f32 v67, v102, v103
  v_cvt_pk_bf16_f32 v68, v104, v105
  v_cvt_pk_bf16_f32 v69, v106, v107
  v_cvt_pk_bf16_f32 v70, v108, v109
  v_cvt_pk_bf16_f32 v71, v110, v111
  buffer_store_dwordx4 v[64:67], v3, s[20:23], s26 offen sc1
  buffer_store_dwordx4 v[68:71], v3, s[20:23], s26 offen offset:1024 sc1
  v_mul_f32 v120, 0x4d800000, v88
  v_fma_f32 v120, v120, 0, 0
  v_fma_f32 v120, v96, 0, v120
  v_fma_f32 v120, v97, 0, v120
  v_fma_f32 v120, v98, 0, v120
  v_fma_f32 v120, v99, 0, v120
  v_fma_f32 v120, v100, 0, v120
  v_fma_f32 v120, v101, 0, v120
  v_fma_f32 v120, v102, 0, v120
  v_fma_f32 v120, v103, 0, v120
  v_fma_f32 v120, v104, 0, v120
  v_fma_f32 v120, v105, 0, v120
  v_fma_f32 v120, v106, 0, v120
  v_fma_f32 v120, v107, 0, v120
  v_fma_f32 v120, v108, 0, v120
  v_fma_f32 v120, v109, 0, v120
  v_fma_f32 v120, v110, 0, v120
  v_fma_f32 v120, v111, 0, v120
  v_cmp_u_f32 vcc, v120, v120
  s_nop 3
  s_cbranch_vccnz P2_SLOWQ
P2_CHKD:
  v_mov_b32 v16, 0
  v_mov_b32 v17, 0
  v_mov_b32 v18, 0
  v_mov_b32 v19, 0
  v_mov_b32 v20, 0
  v_mov_b32 v21, 0
  v_mov_b32 v22, 0
  v_mov_b32 v23, 0
  v_mov_b32 v24, 0
  v_mov_b32 v25, 0
  v_mov_b32 v26, 0
  v_mov_b32 v27, 0
  v_mov_b32 v28, 0
  v_mov_b32 v29, 0
  v_mov_b32 v30, 0
  v_mov_b32 v31, 0
  v_mov_b32 v32, 0
  v_mov_b32 v33, 0
  v_mov_b32 v34, 0
  v_mov_b32 v35, 0
  v_mov_b32 v36, 0
  v_mov_b32 v37, 0
  v_mov_b32 v38, 0
  v_mov_b32 v39, 0
  v_mov_b32 v40, 0
  v_mov_b32 v41, 0
  v_mov_b32 v42, 0
  v_mov_b32 v43, 0
  v_mov_b32 v44, 0
  v_mov_b32 v45, 0
  v_mov_b32 v46, 0
  v_mov_b32 v47, 0
  s_mov_b32 s63, 0
  s_mov_b32 s31, 0x1111
  s_waitcnt vmcnt(2)
  v_cmp_eq_u32 vcc, s64, v124
  v_cmp_eq_u32 s[68:69], s65, v125
  s_nop 1
  s_and_b32 s47, vcc_lo, s68
  s_and_b32 s47, s47, 0xffff
  s_lshr_b32 s48, s47, 1
  s_and_b32 s47, s47, s48
  s_lshr_b32 s48, s47, 2
  s_and_b32 s47, s47, s48
  s_and_b32 s47, s47, 0x1111
  s_or_b32 s63, s63, s47
  s_and_b32 s47, s63, s31
  s_cbranch_scc0 P3_PATHB
  s_ff1_i32_b32 s30, s47
  s_bitset0_b32 s31, s30
  s_lshl_b32 s48, s30, 12
  s_add_u32 s48, s48, s29
  s_lshr_b32 s49, 0x3104, s30
  s_and_b32 s49, s49, 15
  s_lshl_b32 s49, s49, 15
  s_add_u32 s50, s48, 4096
  v_add_u32 v6, s49, v15
  v_xor_b32 v7, 64, v6
  buffer_load_dwordx4 v[128:131], v3, s[20:23], s48 offen offset:0 sc1
  buffer_load_dwordx4 v[132:135], v3, s[20:23], s48 offen offset:1024 sc1
  buffer_load_dwordx4 v[136:139], v3, s[20:23], s48 offen offset:2048 sc1
  buffer_load_dwordx4 v[140:143], v3, s[20:23], s48 offen offset:3072 sc1
  buffer_load_dwordx4 v[144:147], v3, s[20:23], s50 offen offset:0 sc1
  buffer_load_dwordx4 v[148:151], v3, s[20:23], s50 offen offset:1024 sc1
  buffer_load_dwordx4 v[152:155], v3, s[20:23], s50 offen offset:2048 sc1
  buffer_load_dwordx4 v[156:159], v3, s[20:23], s50 offen offset:3072 sc1
  s_waitcnt vmcnt(8)
  v_mov_b32 v122, s64
  v_mov_b32 v123, s65
  v_mov_b32 v120, 0
  s_mov_b64 s[68:69], exec
  s_mov_b64 exec, 1
  buffer_atomic_swap_x2 v[122:123], v120, s[20:23], s27 offen sc1
  s_mov_b64 exec, s[68:69]
  s_barrier
  s_branch P3_JOIN
P3_PATHB:
  s_waitcnt vmcnt(0)
  v_mov_b32 v122, s64
  v_mov_b32 v123, s65
  v_mov_b32 v120, 0
  s_mov_b64 s[68:69], exec
  s_mov_b64 exec, 1
  buffer_atomic_swap_x2 v[122:123], v120, s[20:23], s27 offen sc1
  s_mov_b64 exec, s[68:69]
  s_barrier
P3_E0:
  s_and_b32 s47, s63, s31
  s_cbranch_scc1 P3_G0
  buffer_load_dwordx2 v[122:123], v127, s[20:23], s28 offen sc1
  s_waitcnt vmcnt(0)
  v_cmp_eq_u32 vcc, s64, v122
  v_cmp_eq_u32 s[68:69], s65, v123
  s_nop 1
  s_and_b32 s47, vcc_lo, s68
  s_and_b32 s47, s47, 0xffff
  s_lshr_b32 s48, s47, 1
  s_and_b32 s47, s47, s48
  s_lshr_b32 s48, s47, 2
  s_and_b32 s47, s47, s48
  s_and_b32 s47, s47, 0x1111
  s_or_b32 s63, s63, s47
  s_add_u32 s66, s66, 1
  s_cmp_ge_u32 s66, 131072
  s_cselect_b32 s63, 0x1111, s63
  s_branch P3_E0
P3_G0:
  s_ff1_i32_b32 s30, s47
  s_bitset0_b32 s31, s30
  s_lshl_b32 s48, s30, 12
  s_add_u32 s48, s48, s29
  s_lshr_b32 s49, 0x3104, s30
  s_and_b32 s49, s49, 15
  s_lshl_b32 s49, s49, 15
  s_add_u32 s50, s48, 4096
  v_add_u32 v6, s49, v15
  v_xor_b32 v7, 64, v6
  buffer_load_dwordx4 v[128:131], v3, s[20:23], s48 offen offset:0 sc1
  buffer_load_dwordx4 v[132:135], v3, s[20:23], s48 offen offset:1024 sc1
  buffer_load_dwordx4 v[136:139], v3, s[20:23], s48 offen offset:2048 sc1
  buffer_load_dwordx4 v[140:143], v3, s[20:23], s48 offen offset:3072 sc1
  buffer_load_dwordx4 v[144:147], v3, s[20:23], s50 offen offset:0 sc1
  buffer_load_dwordx4 v[148:151], v3, s[20:23], s50 offen offset:1024 sc1
  buffer_load_dwordx4 v[152:155], v3, s[20:23], s50 offen offset:2048 sc1
  buffer_load_dwordx4 v[156:159], v3, s[20:23], s50 offen offset:3072 sc1
P3_JOIN:
P3_E1:
  s_and_b32 s47, s63, s31
  s_cbranch_scc1 P3_G1
  buffer_load_dwordx2 v[122:123], v127, s[20:23], s28 offen sc1
  s_waitcnt vmcnt(0)
  v_cmp_eq_u32 vcc, s64, v122
  v_cmp_eq_u32 s[68:69], s65, v123
  s_nop 1
  s_and_b32 s47, vcc_lo, s68
  s_and_b32 s47, s47, 0xffff
  s_lshr_b32 s48, s47, 1
  s_and_b32 s47, s47, s48
  s_lshr_b32 s48, s47, 2
  s_and_b32 s47, s47, s48
  s_and_b32 s47, s47, 0x1111
  s_or_b32 s63, s63, s47
  s_add_u32 s66, s66, 1
  s_cmp_ge_u32 s66, 131072
  s_cselect_b32 s63, 0x1111, s63
  s_branch P3_E1
P3_G1:
  s_ff1_i32_b32 s30, s47
  s_bitset0_b32 s31, s30
  s_lshl_b32 s48, s30, 12
  s_add_u32 s48, s48, s29
  s_lshr_b32 s49, 0x3104, s30
  s_and_b32 s49, s49, 15
  s_lshl_b32 s49, s49, 15
  s_add_u32 s50, s48, 4096
  v_add_u32 v8, s49, v15
  v_xor_b32 v9, 64, v8
  buffer_load_dwordx2 v[124:125], v127, s[20:23], s28 offen sc1
  buffer_load_dwordx4 v[160:163], v3, s[20:23], s48 offen offset:0 sc1
  buffer_load_dwordx4 v[164:167], v3, s[20:23], s48 offen offset:1024 sc1
  buffer_load_dwordx4 v[168:171], v3, s[20:23], s48 offen offset:2048 sc1
  buffer_load_dwordx4 v[172:175], v3, s[20:23], s48 offen offset:3072 sc1
  buffer_load_dwordx4 v[176:179], v3, s[20:23], s50 offen offset:0 sc1
  buffer_load_dwordx4 v[180:183], v3, s[20:23], s50 offen offset:1024 sc1
  buffer_load_dwordx4 v[184:187], v3, s[20:23], s50 offen offset:2048 sc1
  buffer_load_dwordx4 v[188:191], v3, s[20:23], s50 offen offset:3072 sc1
  ds_read_b64_tr_b16 v[48:49], v6 offset:0
  ds_read_b64_tr_b16 v[50:51], v6 offset:1024
  ds_read_b64_tr_b16 v[52:53], v7 offset:0
  ds_read_b64_tr_b16 v[54:55], v7 offset:1024
  ds_read_b64_tr_b16 v[56:57], v6 offset:2048
  ds_read_b64_tr_b16 v[58:59], v6 offset:3072
  ds_read_b64_tr_b16 v[60:61], v7 offset:2048
  ds_read_b64_tr_b16 v[62:63], v7 offset:3072
  s_waitcnt vmcnt(16) lgkmcnt(4)
  v_mfma_f32_32x32x16_bf16 v[16:31], v[48:51], v[128:131], v[16:31]
  v_mfma_f32_32x32x16_bf16 v[32:47], v[52:55], v[128:131], v[32:47]
  ds_read_b64_tr_b16 v[48:49], v6 offset:4096
  ds_read_b64_tr_b16 v[50:51], v6 offset:5120
  ds_read_b64_tr_b16 v[52:53], v7 offset:4096
  ds_read_b64_tr_b16 v[54:55], v7 offset:5120
  s_waitcnt vmcnt(15) lgkmcnt(4)
  v_mfma_f32_32x32x16_bf16 v[16:31], v[56:59], v[132:135], v[16:31]
  v_mfma_f32_32x32x16_bf16 v[32:47], v[60:63], v[132:135], v[32:47]
  ds_read_b64_tr_b16 v[56:57], v6 offset:6144
  ds_read_b64_tr_b16 v[58:59], v6 offset:7168
  ds_read_b64_tr_b16 v[60:61], v7 offset:6144
  ds_read_b64_tr_b16 v[62:63], v7 offset:7168
  s_waitcnt vmcnt(14) lgkmcnt(4)
  v_mfma_f32_32x32x16_bf16 v[16:31], v[48:51], v[136:139], v[16:31]
  v_mfma_f32_32x32x16_bf16 v[32:47], v[52:55], v[136:139], v[32:47]
  ds_read_b64_tr_b16 v[48:49], v6 offset:8192
  ds_read_b64_tr_b16 v[50:51], v6 offset:9216
  ds_read_b64_tr_b16 v[52:53], v7 offset:8192
  ds_read_b64_tr_b16 v[54:55], v7 offset:9216
  s_waitcnt vmcnt(13) lgkmcnt(4)
  v_mfma_f32_32x32x16_bf16 v[16:31], v[56:59], v[140:143], v[16:31]
  v_mfma_f32_32x32x16_bf16 v[32:47], v[60:63], v[140:143], v[32:47]
  ds_read_b64_tr_b16 v[56:57], v6 offset:10240
  ds_read_b64_tr_b16 v[58:59], v6 offset:11264
  ds_read_b64_tr_b16 v[60:61], v7 offset:10240
  ds_read_b64_tr_b16 v[62:63], v7 offset:11264
  s_waitcnt vmcnt(12) lgkmcnt(4)
  v_mfma_f32_32x32x16_bf16 v[16:31], v[48:51], v[144:147], v[16:31]
  v_mfma_f32_32x32x16_bf16 v[32:47], v[52:55], v[144:147], v[32:47]
  ds_read_b64_tr_b16 v[48:49], v6 offset:12288
  ds_read_b64_tr_b16 v[50:51], v6 offset:13312
  ds_read_b64_tr_b16 v[52:53], v7 offset:12288
  ds_read_b64_tr_b16 v[54:55], v7 offset:13312
  s_waitcnt vmcnt(11) lgkmcnt(4)
  v_mfma_f32_32x32x16_bf16 v[16:31], v[56:59], v[148:151], v[16:31]
  v_mfma_f32_32x32x16_bf16 v[32:47], v[60:63], v[148:151], v[32:47]
  ds_read_b64_tr_b16 v[56:57], v6 offset:14336
  ds_read_b64_tr_b16 v[58:59], v6 offset:15360
  ds_read_b64_tr_b16 v[60:61], v7 offset:14336
  ds_read_b64_tr_b16 v[62:63], v7 offset:15360
  s_waitcnt vmcnt(10) lgkmcnt(4)
  v_mfma_f32_32x32x16_bf16 v[16:31], v[48:51], v[152:155], v[16:31]
  v_mfma_f32_32x32x16_bf16 v[32:47], v[52:55], v[152:155], v[32:47]
  ds_read_b64_tr_b16 v[48:49], v8 offset:0
  ds_read_b64_tr_b16 v[50:51], v8 offset:1024
  ds_read_b64_tr_b16 v[52:53], v9 offset:0
  ds_read_b64_tr_b16 v[54:55], v9 offset:1024
  s_waitcnt vmcnt(9) lgkmcnt(4)
  v_mfma_f32_32x32x16_bf16 v[16:31], v[56:59], v[156:159], v[16:31]
  v_mfma_f32_32x32x16_bf16 v[32:47], v[60:63], v[156:159], v[32:47]
  s_waitcnt vmcnt(8)
  v_cmp_eq_u32 vcc, s64, v124
  v_cmp_eq_u32 s[68:69], s65, v125
  s_nop 1
  s_and_b32 s47, vcc_lo, s68
  s_and_b32 s47, s47, 0xffff
  s_lshr_b32 s48, s47, 1
  s_and_b32 s47, s47, s48
  s_lshr_b32 s48, s47, 2
  s_and_b32 s47, s47, s48
  s_and_b32 s47, s47, 0x1111
  s_or_b32 s63, s63, s47
P3_E2:
  s_and_b32 s47, s63, s31
  s_cbranch_scc1 P3_G2
  buffer_load_dwordx2 v[122:123], v127, s[20:23], s28 offen sc1
  s_waitcnt vmcnt(0)
  v_cmp_eq_u32 vcc, s64, v122
  v_cmp_eq_u32 s[68:69], s65, v123
  s_nop 1
  s_and_b32 s47, vcc_lo, s68
  s_and_b32 s47, s47, 0xffff
  s_lshr_b32 s48, s47, 1
  s_and_b32 s47, s47, s48
  s_lshr_b32 s48, s47, 2
  s_and_b32 s47, s47, s48
  s_and_b32 s47, s47, 0x1111
  s_or_b32 s63, s63, s47
  s_add_u32 s66, s66, 1
  s_cmp_ge_u32 s66, 131072
  s_cselect_b32 s63, 0x1111, s63
  s_branch P3_E2
P3_G2:
  s_ff1_i32_b32 s30, s47
  s_bitset0_b32 s31, s30
  s_lshl_b32 s48, s30, 12
  s_add_u32 s48, s48, s29
  s_lshr_b32 s49, 0x3104, s30
  s_and_b32 s49, s49, 15
  s_lshl_b32 s49, s49, 15
  s_add_u32 s50, s48, 4096
  v_add_u32 v10, s49, v15
  v_xor_b32 v11, 64, v10
  buffer_load_dwordx2 v[124:125], v127, s[20:23], s28 offen sc1
  buffer_load_dwordx4 v[192:195], v3, s[20:23], s48 offen offset:0 sc1
  buffer_load_dwordx4 v[196:199], v3, s[20:23], s48 offen offset:1024 sc1
  buffer_load_dwordx4 v[200:203], v3, s[20:23], s48 offen offset:2048 sc1
  buffer_load_dwordx4 v[204:207], v3, s[20:23], s48 offen offset:3072 sc1
  buffer_load_dwordx4 v[208:211], v3, s[20:23], s50 offen offset:0 sc1
  buffer_load_dwordx4 v[212:215], v3, s[20:23], s50 offen offset:1024 sc1
  buffer_load_dwordx4 v[216:219], v3, s[20:23], s50 offen offset:2048 sc1
  buffer_load_dwordx4 v[220:223], v3, s[20:23], s50 offen offset:3072 sc1
  ds_read_b64_tr_b16 v[56:57], v8 offset:2048
  ds_read_b64_tr_b16 v[58:59], v8 offset:3072
  ds_read_b64_tr_b16 v[60:61], v9 offset:2048
  ds_read_b64_tr_b16 v[62:63], v9 offset:3072
  s_waitcnt vmcnt(16) lgkmcnt(4)
  v_mfma_f32_32x32x16_bf16 v[16:31], v[48:51], v[160:163], v[16:31]
  v_mfma_f32_32x32x16_bf16 v[32:47], v[52:55], v[160:163], v[32:47]
  ds_read_b64_tr_b16 v[48:49], v8 offset:4096
  ds_read_b64_tr_b16 v[50:51], v8 offset:5120
  ds_read_b64_tr_b16 v[52:53], v9 offset:4096
  ds_read_b64_tr_b16 v[54:55], v9 offset:5120
  s_waitcnt vmcnt(15) lgkmcnt(4)
  v_mfma_f32_32x32x16_bf16 v[16:31], v[56:59], v[164:167], v[16:31]
  v_mfma_f32_32x32x16_bf16 v[32:47], v[60:63], v[164:167], v[32:47]
  ds_read_b64_tr_b16 v[56:57], v8 offset:6144
  ds_read_b64_tr_b16 v[58:59], v8 offset:7168
  ds_read_b64_tr_b16 v[60:61], v9 offset:6144
  ds_read_b64_tr_b16 v[62:63], v9 offset:7168
  s_waitcnt vmcnt(14) lgkmcnt(4)
  v_mfma_f32_32x32x16_bf16 v[16:31], v[48:51], v[168:171], v[16:31]
  v_mfma_f32_32x32x16_bf16 v[32:47], v[52:55], v[168:171], v[32:47]
  ds_read_b64_tr_b16 v[48:49], v8 offset:8192
  ds_read_b64_tr_b16 v[50:51], v8 offset:9216
  ds_read_b64_tr_b16 v[52:53], v9 offset:8192
  ds_read_b64_tr_b16 v[54:55], v9 offset:9216
  s_waitcnt vmcnt(13) lgkmcnt(4)
  v_mfma_f32_32x32x16_bf16 v[16:31], v[56:59], v[172:175], v[16:31]
  v_mfma_f32_32x32x16_bf16 v[32:47], v[60:63], v[172:175], v[32:47]
  ds_read_b64_tr_b16 v[56:57], v8 offset:10240
  ds_read_b64_tr_b16 v[58:59], v8 offset:11264
  ds_read_b64_tr_b16 v[60:61], v9 offset:10240
  ds_read_b64_tr_b16 v[62:63], v9 offset:11264
  s_waitcnt vmcnt(12) lgkmcnt(4)
  v_mfma_f32_32x32x16_bf16 v[16:31], v[48:51], v[176:179], v[16:31]
  v_mfma_f32_32x32x16_bf16 v[32:47], v[52:55], v[176:179], v[32:47]
  ds_read_b64_tr_b16 v[48:49], v8 offset:12288
  ds_read_b64_tr_b16 v[50:51], v8 offset:13312
  ds_read_b64_tr_b16 v[52:53], v9 offset:12288
  ds_read_b64_tr_b16 v[54:55], v9 offset:13312
  s_waitcnt vmcnt(11) lgkmcnt(4)
  v_mfma_f32_32x32x16_bf16 v[16:31], v[56:59], v[180:183], v[16:31]
  v_mfma_f32_32x32x16_bf16 v[32:47], v[60:63], v[180:183], v[32:47]
  ds_read_b64_tr_b16 v[56:57], v8 offset:14336
  ds_read_b64_tr_b16 v[58:59], v8 offset:15360
  ds_read_b64_tr_b16 v[60:61], v9 offset:14336
  ds_read_b64_tr_b16 v[62:63], v9 offset:15360
  s_waitcnt vmcnt(10) lgkmcnt(4)
  v_mfma_f32_32x32x16_bf16 v[16:31], v[48:51], v[184:187], v[16:31]
  v_mfma_f32_32x32x16_bf16 v[32:47], v[52:55], v[184:187], v[32:47]
  ds_read_b64_tr_b16 v[48:49], v10 offset:0
  ds_read_b64_tr_b16 v[50:51], v10 offset:1024
  ds_read_b64_tr_b16 v[52:53], v11 offset:0
  ds_read_b64_tr_b16 v[54:55], v11 offset:1024
  s_waitcnt vmcnt(9) lgkmcnt(4)
  v_mfma_f32_32x32x16_bf16 v[16:31], v[56:59], v[188:191], v[16:31]
  v_mfma_f32_32x32x16_bf16 v[32:47], v[60:63], v[188:191], v[32:47]
  s_waitcnt vmcnt(8)
  v_cmp_eq_u32 vcc, s64, v124
  v_cmp_eq_u32 s[68:69], s65, v125
  s_nop 1
  s_and_b32 s47, vcc_lo, s68
  s_and_b32 s47, s47, 0xffff
  s_lshr_b32 s48, s47, 1
  s_and_b32 s47, s47, s48
  s_lshr_b32 s48, s47, 2
  s_and_b32 s47, s47, s48
  s_and_b32 s47, s47, 0x1111
  s_or_b32 s63, s63, s47
P3_E3:
  s_and_b32 s47, s63, s31
  s_cbranch_scc1 P3_G3
  buffer_load_dwordx2 v[122:123], v127, s[20:23], s28 offen sc1
  s_waitcnt vmcnt(0)
  v_cmp_eq_u32 vcc, s64, v122
  v_cmp_eq_u32 s[68:69], s65, v123
  s_nop 1
  s_and_b32 s47, vcc_lo, s68
  s_and_b32 s47, s47, 0xffff
  s_lshr_b32 s48, s47, 1
  s_and_b32 s47, s47, s48
  s_lshr_b32 s48, s47, 2
  s_and_b32 s47, s47, s48
  s_and_b32 s47, s47, 0x1111
  s_or_b32 s63, s63, s47
  s_add_u32 s66, s66, 1
  s_cmp_ge_u32 s66, 131072
  s_cselect_b32 s63, 0x1111, s63
  s_branch P3_E3
P3_G3:
  s_ff1_i32_b32 s30, s47
  s_bitset0_b32 s31, s30
  s_lshl_b32 s48, s30, 12
  s_add_u32 s48, s48, s29
  s_lshr_b32 s49, 0x3104, s30
  s_and_b32 s49, s49, 15
  s_lshl_b32 s49, s49, 15
  s_add_u32 s50, s48, 4096
  v_add_u32 v12, s49, v15
  v_xor_b32 v13, 64, v12
  buffer_load_dwordx4 v[224:227], v3, s[20:23], s48 offen offset:0 sc1
  buffer_load_dwordx4 v[228:231], v3, s[20:23], s48 offen offset:1024 sc1
  buffer_load_dwordx4 v[232:235], v3, s[20:23], s48 offen offset:2048 sc1
  buffer_load_dwordx4 v[236:239], v3, s[20:23], s48 offen offset:3072 sc1
  buffer_load_dwordx4 v[240:243], v3, s[20:23], s50 offen offset:0 sc1
  buffer_load_dwordx4 v[244:247], v3, s[20:23], s50 offen offset:1024 sc1
  buffer_load_dwordx4 v[248:251], v3, s[20:23], s50 offen offset:2048 sc1
  buffer_load_dwordx4 v[252:255], v3, s[20:23], s50 offen offset:3072 sc1
  ds_read_b64_tr_b16 v[56:57], v10 offset:2048
  ds_read_b64_tr_b16 v[58:59], v10 offset:3072
  ds_read_b64_tr_b16 v[60:61], v11 offset:2048
  ds_read_b64_tr_b16 v[62:63], v11 offset:3072
  s_waitcnt vmcnt(15) lgkmcnt(4)
  v_mfma_f32_32x32x16_bf16 v[16:31], v[48:51], v[192:195], v[16:31]
  v_mfma_f32_32x32x16_bf16 v[32:47], v[52:55], v[192:195], v[32:47]
  ds_read_b64_tr_b16 v[48:49], v10 offset:4096
  ds_read_b64_tr_b16 v[50:51], v10 offset:5120
  ds_read_b64_tr_b16 v[52:53], v11 offset:4096
  ds_read_b64_tr_b16 v[54:55], v11 offset:5120
  s_waitcnt vmcnt(14) lgkmcnt(4)
  v_mfma_f32_32x32x16_bf16 v[16:31], v[56:59], v[196:199], v[16:31]
  v_mfma_f32_32x32x16_bf16 v[32:47], v[60:63], v[196:199], v[32:47]
  ds_read_b64_tr_b16 v[56:57], v10 offset:6144
  ds_read_b64_tr_b16 v[58:59], v10 offset:7168
  ds_read_b64_tr_b16 v[60:61], v11 offset:6144
  ds_read_b64_tr_b16 v[62:63], v11 offset:7168
  s_waitcnt vmcnt(13) lgkmcnt(4)
  v_mfma_f32_32x32x16_bf16 v[16:31], v[48:51], v[200:203], v[16:31]
  v_mfma_f32_32x32x16_bf16 v[32:47], v[52:55], v[200:203], v[32:47]
  ds_read_b64_tr_b16 v[48:49], v10 offset:8192
  ds_read_b64_tr_b16 v[50:51], v10 offset:9216
  ds_read_b64_tr_b16 v[52:53], v11 offset:8192
  ds_read_b64_tr_b16 v[54:55], v11 offset:9216
  s_waitcnt vmcnt(12) lgkmcnt(4)
  v_mfma_f32_32x32x16_bf16 v[16:31], v[56:59], v[204:207], v[16:31]
  v_mfma_f32_32x32x16_bf16 v[32:47], v[60:63], v[204:207], v[32:47]
  ds_read_b64_tr_b16 v[56:57], v10 offset:10240
  ds_read_b64_tr_b16 v[58:59], v10 offset:11264
  ds_read_b64_tr_b16 v[60:61], v11 offset:10240
  ds_read_b64_tr_b16 v[62:63], v11 offset:11264
  s_waitcnt vmcnt(11) lgkmcnt(4)
  v_mfma_f32_32x32x16_bf16 v[16:31], v[48:51], v[208:211], v[16:31]
  v_mfma_f32_32x32x16_bf16 v[32:47], v[52:55], v[208:211], v[32:47]
  ds_read_b64_tr_b16 v[48:49], v10 offset:12288
  ds_read_b64_tr_b16 v[50:51], v10 offset:13312
  ds_read_b64_tr_b16 v[52:53], v11 offset:12288
  ds_read_b64_tr_b16 v[54:55], v11 offset:13312
  s_waitcnt vmcnt(10) lgkmcnt(4)
  v_mfma_f32_32x32x16_bf16 v[16:31], v[56:59], v[212:215], v[16:31]
  v_mfma_f32_32x32x16_bf16 v[32:47], v[60:63], v[212:215], v[32:47]
  ds_read_b64_tr_b16 v[56:57], v10 offset:14336
  ds_read_b64_tr_b16 v[58:59], v10 offset:15360
  ds_read_b64_tr_b16 v[60:61], v11 offset:14336
  ds_read_b64_tr_b16 v[62:63], v11 offset:15360
  s_waitcnt vmcnt(9) lgkmcnt(4)
  v_mfma_f32_32x32x16_bf16 v[16:31], v[48:51], v[216:219], v[16:31]
  v_mfma_f32_32x32x16_bf16 v[32:47], v[52:55], v[216:219], v[32:47]
  ds_read_b64_tr_b16 v[48:49], v12 offset:0
  ds_read_b64_tr_b16 v[50:51], v12 offset:1024
  ds_read_b64_tr_b16 v[52:53], v13 offset:0
  ds_read_b64_tr_b16 v[54:55], v13 offset:1024
  s_waitcnt vmcnt(8) lgkmcnt(4)
  v_mfma_f32_32x32x16_bf16 v[16:31], v[56:59], v[220:223], v[16:31]
  v_mfma_f32_32x32x16_bf16 v[32:47], v[60:63], v[220:223], v[32:47]
  s_lshl_b32 s48, s18, 12
  s_add_u32 s48, s48, 65536
  v_add_u32 v6, s48, v3
  s_xor_b32 s49, s18, 4
  s_lshl_b32 s49, s49, 12
  s_add_u32 s49, s49, 65536
  v_add_u32 v7, s49, v3
  v_and_b32 v1, 31, v0
  s_and_b32 s47, s18, 3
  s_lshl_b32 s48, s45, 2
  s_add_u32 s47, s47, s48
  s_lshl_b32 s47, s47, 5
  v_add_u32 v1, s47, v1
  v_lshlrev_b32 v1, 11, v1
  v_lshrrev_b32 v2, 5, v0
  v_lshlrev_b32 v2, 4, v2
  v_add_u32 v1, v1, v2
  s_lshr_b32 s50, s18, 2
  s_lshl_b32 s51, s46, 7
  s_lshl_b32 s52, s50, 6
  s_add_u32 s51, s51, s52
  v_add_u32 v1, s51, v1
  s_cmp_eq_u32 s50, 0
  s_cbranch_scc1 P3_KH0
  ds_read_b64_tr_b16 v[56:57], v12 offset:2048
  ds_read_b64_tr_b16 v[58:59], v12 offset:3072
  s_waitcnt vmcnt(7) lgkmcnt(2)
  v_mfma_f32_32x32x16_bf16 v[16:31], v[48:51], v[224:227], v[16:31]
  ds_read_b64_tr_b16 v[48:49], v12 offset:4096
  ds_read_b64_tr_b16 v[50:51], v12 offset:5120
  s_waitcnt vmcnt(6) lgkmcnt(2)
  v_mfma_f32_32x32x16_bf16 v[16:31], v[56:59], v[228:231], v[16:31]
  ds_read_b64_tr_b16 v[56:57], v12 offset:6144
  ds_read_b64_tr_b16 v[58:59], v12 offset:7168
  s_waitcnt vmcnt(5) lgkmcnt(2)
  v_mfma_f32_32x32x16_bf16 v[16:31], v[48:51], v[232:235], v[16:31]
  ds_read_b64_tr_b16 v[48:49], v12 offset:8192
  ds_read_b64_tr_b16 v[50:51], v12 offset:9216
  s_waitcnt vmcnt(4) lgkmcnt(2)
  v_mfma_f32_32x32x16_bf16 v[16:31], v[56:59], v[236:239], v[16:31]
  ds_read_b64_tr_b16 v[56:57], v12 offset:10240
  ds_read_b64_tr_b16 v[58:59], v12 offset:11264
  s_waitcnt vmcnt(3) lgkmcnt(2)
  v_mfma_f32_32x32x16_bf16 v[16:31], v[48:51], v[240:243], v[16:31]
  ds_read_b64_tr_b16 v[48:49], v12 offset:12288
  ds_read_b64_tr_b16 v[50:51], v12 offset:13312
  s_waitcnt vmcnt(2) lgkmcnt(2)
  v_mfma_f32_32x32x16_bf16 v[16:31], v[56:59], v[244:247], v[16:31]
  ds_read_b64_tr_b16 v[56:57], v12 offset:14336
  ds_read_b64_tr_b16 v[58:59], v12 offset:15360
  s_waitcnt vmcnt(1) lgkmcnt(2)
  v_mfma_f32_32x32x16_bf16 v[16:31], v[48:51], v[248:251], v[16:31]
  ds_read_b64_tr_b16 v[60:61], v13 offset:2048
  ds_read_b64_tr_b16 v[62:63], v13 offset:3072
  s_waitcnt vmcnt(0) lgkmcnt(2)
  v_mfma_f32_32x32x16_bf16 v[16:31], v[56:59], v[252:255], v[16:31]
  v_mfma_f32_32x32x16_bf16 v[32:47], v[52:55], v[224:227], v[32:47]
  ds_read_b64_tr_b16 v[52:53], v13 offset:4096
  ds_read_b64_tr_b16 v[54:55], v13 offset:5120
  s_waitcnt lgkmcnt(2)
  v_mfma_f32_32x32x16_bf16 v[32:47], v[60:63], v[228:231], v[32:47]
  ds_read_b64_tr_b16 v[60:61], v13 offset:6144
  ds_read_b64_tr_b16 v[62:63], v13 offset:7168
  s_nop 7
  s_nop 3
  ds_write_b128 v6, v[16:19] offset:0
  ds_write_b128 v6, v[20:23] offset:1024
  ds_write_b128 v6, v[24:27] offset:2048
  ds_write_b128 v6, v[28:31] offset:3072
  s_waitcnt lgkmcnt(6)
  v_mfma_f32_32x32x16_bf16 v[32:47], v[52:55], v[232:235], v[32:47]
  ds_read_b64_tr_b16 v[52:53], v13 offset:8192
  ds_read_b64_tr_b16 v[54:55], v13 offset:9216
  s_waitcnt lgkmcnt(6)
  v_mfma_f32_32x32x16_bf16 v[32:47], v[60:63], v[236:239], v[32:47]
  ds_read_b64_tr_b16 v[60:61], v13 offset:10240
  ds_read_b64_tr_b16 v[62:63], v13 offset:11264
  s_waitcnt lgkmcnt(0)
  s_barrier
  ds_read_b128 v[64:67], v7 offset:0
  ds_read_b128 v[68:71], v7 offset:1024
  ds_read_b128 v[72:75], v7 offset:2048
  ds_read_b128 v[76:79], v7 offset:3072
  v_mfma_f32_32x32x16_bf16 v[32:47], v[52:55], v[240:243], v[32:47]
  ds_read_b64_tr_b16 v[52:53], v13 offset:12288
  ds_read_b64_tr_b16 v[54:55], v13 offset:13312
  v_mfma_f32_32x32x16_bf16 v[32:47], v[60:63], v[244:247], v[32:47]
  ds_read_b64_tr_b16 v[60:61], v13 offset:14336
  ds_read_b64_tr_b16 v[62:63], v13 offset:15360
  s_waitcnt lgkmcnt(2)
  v_mfma_f32_32x32x16_bf16 v[32:47], v[52:55], v[248:251], v[32:47]
  s_waitcnt lgkmcnt(0)
  v_mfma_f32_32x32x16_bf16 v[32:47], v[60:63], v[252:255], v[32:47]
  s_nop 15
  s_nop 3
  v_add_f32 v64, v64, v32
  v_add_f32 v65, v65, v33
  v_add_f32 v66, v66, v34
  v_add_f32 v67, v67, v35
  v_add_f32 v68, v68, v36
  v_add_f32 v69, v69, v37
  v_add_f32 v70, v70, v38
  v_add_f32 v71, v71, v39
  v_add_f32 v72, v72, v40
  v_add_f32 v73, v73, v41
  v_add_f32 v74, v74, v42
  v_add_f32 v75, v75, v43
  v_add_f32 v76, v76, v44
  v_add_f32 v77, v77, v45
  v_add_f32 v78, v78, v46
  v_add_f32 v79, v79, v47
  s_branch P3_FIN
P3_KH0:
  ds_read_b64_tr_b16 v[60:61], v13 offset:2048
  ds_read_b64_tr_b16 v[62:63], v13 offset:3072
  s_waitcnt vmcnt(7) lgkmcnt(2)
  v_mfma_f32_32x32x16_bf16 v[32:47], v[52:55], v[224:227], v[32:47]
  ds_read_b64_tr_b16 v[52:53], v13 offset:4096
  ds_read_b64_tr_b16 v[54:55], v13 offset:5120
  s_waitcnt vmcnt(6) lgkmcnt(2)
  v_mfma_f32_32x32x16_bf16 v[32:47], v[60:63], v[228:231], v[32:47]
  ds_read_b64_tr_b16 v[60:61], v13 offset:6144
  ds_read_b64_tr_b16 v[62:63], v13 offset:7168
  s_waitcnt vmcnt(5) lgkmcnt(2)
  v_mfma_f32_32x32x16_bf16 v[32:47], v[52:55], v[232:235], v[32:47]
  ds_read_b64_tr_b16 v[52:53], v13 offset:8192
  ds_read_b64_tr_b16 v[54:55], v13 offset:9216
  s_waitcnt vmcnt(4) lgkmcnt(2)
  v_mfma_f32_32x32x16_bf16 v[32:47], v[60:63], v[236:239], v[32:47]
  ds_read_b64_tr_b16 v[60:61], v13 offset:10240
  ds_read_b64_tr_b16 v[62:63], v13 offset:11264
  s_waitcnt vmcnt(3) lgkmcnt(2)
  v_mfma_f32_32x32x16_bf16 v[32:47], v[52:55], v[240:243], v[32:47]
  ds_read_b64_tr_b16 v[52:53], v13 offset:12288
  ds_read_b64_tr_b16 v[54:55], v13 offset:13312
  s_waitcnt vmcnt(2) lgkmcnt(2)
  v_mfma_f32_32x32x16_bf16 v[32:47], v[60:63], v[244:247], v[32:47]
  ds_read_b64_tr_b16 v[60:61], v13 offset:14336
  ds_read_b64_tr_b16 v[62:63], v13 offset:15360
  s_waitcnt vmcnt(1) lgkmcnt(2)
  v_mfma_f32_32x32x16_bf16 v[32:47], v[52:55], v[248:251], v[32:47]
  ds_read_b64_tr_b16 v[56:57], v12 offset:2048
  ds_read_b64_tr_b16 v[58:59], v12 offset:3072
  s_waitcnt vmcnt(0) lgkmcnt(2)
  v_mfma_f32_32x32x16_bf16 v[32:47], v[60:63], v[252:255], v[32:47]
  v_mfma_f32_32x32x16_bf16 v[16:31], v[48:51], v[224:227], v[16:31]
  ds_read_b64_tr_b16 v[48:49], v12 offset:4096
  ds_read_b64_tr_b16 v[50:51], v12 offset:5120
  s_waitcnt lgkmcnt(2)
  v_mfma_f32_32x32x16_bf16 v[16:31], v[56:59], v[228:231], v[16:31]
  ds_read_b64_tr_b16 v[56:57], v12 offset:6144
  ds_read_b64_tr_b16 v[58:59], v12 offset:7168
  s_nop 7
  s_nop 3
  ds_write_b128 v6, v[32:35] offset:0
  ds_write_b128 v6, v[36:39] offset:1024
  ds_write_b128 v6, v[40:43] offset:2048
  ds_write_b128 v6, v[44:47] offset:3072
  s_waitcnt lgkmcnt(6)
  v_mfma_f32_32x32x16_bf16 v[16:31], v[48:51], v[232:235], v[16:31]
  ds_read_b64_tr_b16 v[48:49], v12 offset:8192
  ds_read_b64_tr_b16 v[50:51], v12 offset:9216
  s_waitcnt lgkmcnt(6)
  v_mfma_f32_32x32x16_bf16 v[16:31], v[56:59], v[236:239], v[16:31]
  ds_read_b64_tr_b16 v[56:57], v12 offset:10240
  ds_read_b64_tr_b16 v[58:59], v12 offset:11264
  s_waitcnt lgkmcnt(0)
  s_barrier
  ds_read_b128 v[64:67], v7 offset:0
  ds_read_b128 v[68:71], v7 offset:1024
  ds_read_b128 v[72:75], v7 offset:2048
  ds_read_b128 v[76:79], v7 offset:3072
  v_mfma_f32_32x32x16_bf16 v[16:31], v[48:51], v[240:243], v[16:31]
  ds_read_b64_tr_b16 v[48:49], v12 offset:12288
  ds_read_b64_tr_b16 v[50:51], v12 offset:13312
  v_mfma_f32_32x32x16_bf16 v[16:31], v[56:59], v[244:247], v[16:31]
  ds_read_b64_tr_b16 v[56:57], v12 offset:14336
  ds_read_b64_tr_b16 v[58:59], v12 offset:15360
  s_waitcnt lgkmcnt(2)
  v_mfma_f32_32x32x16_bf16 v[16:31], v[48:51], v[248:251], v[16:31]
  s_waitcnt lgkmcnt(0)
  v_mfma_f32_32x32x16_bf16 v[16:31], v[56:59], v[252:255], v[16:31]
  s_nop 15
  s_nop 3
  v_add_f32 v64, v64, v16
  v_add_f32 v65, v65, v17
  v_add_f32 v66, v66, v18
  v_add_f32 v67, v67, v19
  v_add_f32 v68, v68, v20
  v_add_f32 v69, v69, v21
  v_add_f32 v70, v70, v22
  v_add_f32 v71, v71, v23
  v_add_f32 v72, v72, v24
  v_add_f32 v73, v73, v25
  v_add_f32 v74, v74, v26
  v_add_f32 v75, v75, v27
  v_add_f32 v76, v76, v28
  v_add_f32 v77, v77, v29
  v_add_f32 v78, v78, v30
  v_add_f32 v79, v79, v31
P3_FIN:
  v_cvt_pk_bf16_f32 v80, v64, v65
  v_cvt_pk_bf16_f32 v81, v66, v67
  v_cvt_pk_bf16_f32 v82, v68, v69
  v_cvt_pk_bf16_f32 v83, v70, v71
  v_cvt_pk_bf16_f32 v84, v72, v73
  v_cvt_pk_bf16_f32 v85, v74, v75
  v_cvt_pk_bf16_f32 v86, v76, v77
  v_cvt_pk_bf16_f32 v87, v78, v79
  s_nop 1
  v_permlane32_swap_b32 v80, v82
  v_permlane32_swap_b32 v81, v83
  v_permlane32_swap_b32 v84, v86
  v_permlane32_swap_b32 v85, v87
  s_nop 1
  buffer_store_dwordx4 v[80:83], v1, s[32:35], 0 offen
  buffer_store_dwordx4 v[84:87], v1, s[32:35], 0 offen offset:32
  s_endpgm
P1_J0_0:
  global_load_dword v207, v203, s[88:89]
  s_branch P1_JB0_0
P1_J1_0:
  global_load_dword v207, v204, s[88:89]
  s_branch P1_JB1_0
P2_SLOWQ:
  s_cmp_eq_u32 s67, 7
  s_cbranch_scc1 P2_CHKD
  s_mov_b32 s67, 7
P2_SLOW:
  s_lshl_b32 s47, s16, 1
  s_add_u32 s47, s47, s19
  s_lshl_b32 s47, s47, 18
  v_mov_b32 v16, 0xff800000
  s_mov_b32 s48, 0
P2_SLOW1:
  s_add_u32 s49, s47, s48
  buffer_load_dwordx4 v[72:75], v3, s[20:23], s49 offen sc1
  buffer_load_dwordx4 v[76:79], v3, s[20:23], s49 offen offset:1024 sc1
  s_waitcnt vmcnt(0)
  v_mfma_f32_32x32x16_bf16 v[32:47], v[72:75], v[4:7], 0
  v_mfma_f32_32x32x16_bf16 v[32:47], v[76:79], v[8:11], v[32:47]
  s_nop 15
  v_max3_f32 v16, v16, v32, v33
  v_max3_f32 v16, v16, v34, v35
  v_max3_f32 v16, v16, v36, v37
  v_max3_f32 v16, v16, v38, v39
  v_max3_f32 v16, v16, v40, v41
  v_max3_f32 v16, v16, v42, v43
  v_max3_f32 v16, v16, v44, v45
  v_max3_f32 v16, v16, v46, v47
  s_add_u32 s48, s48, 4096
  s_cmp_lt_u32 s48, 262144
  s_cbranch_scc1 P2_SLOW1
  v_mov_b32 v17, v16
  s_nop 1
  v_permlane32_swap_b32 v16, v17
  s_nop 1
  v_max_f32 v16, v16, v17
  v_sub_f32 v16, 0, v16
  v_mov_b32 v17, v16
  v_mov_b32 v18, v16
  v_mov_b32 v19, v16
  v_mov_b32 v20, v16
  v_mov_b32 v21, v16
  v_mov_b32 v22, v16
  v_mov_b32 v23, v16
  v_mov_b32 v24, v16
  v_mov_b32 v25, v16
  v_mov_b32 v26, v16
  v_mov_b32 v27, v16
  v_mov_b32 v28, v16
  v_mov_b32 v29, v16
  v_mov_b32 v30, v16
  v_mov_b32 v31, v16
  v_mov_b32 v96, 0
  v_mov_b32 v97, 0
  v_mov_b32 v98, 0
  v_mov_b32 v99, 0
  v_mov_b32 v100, 0
  v_mov_b32 v101, 0
  v_mov_b32 v102, 0
  v_mov_b32 v103, 0
  v_mov_b32 v104, 0
  v_mov_b32 v105, 0
  v_mov_b32 v106, 0
  v_mov_b32 v107, 0
  v_mov_b32 v108, 0
  v_mov_b32 v109, 0
  v_mov_b32 v110, 0
  v_mov_b32 v111, 0
  v_mov_b32 v88, 0
  v_mov_b32 v89, 0
  v_mov_b32 v90, 0
  v_mov_b32 v91, 0
  s_mov_b32 s48, 0
P2_SLOW2:
  s_add_u32 s49, s47, s48
  buffer_load_dwordx4 v[72:75], v3, s[20:23], s49 offen sc1
  buffer_load_dwordx4 v[76:79], v3, s[20:23], s49 offen offset:1024 sc1
  buffer_load_dwordx4 v[80:83], v3, s[20:23], s49 offen offset:2048 sc1
  buffer_load_dwordx4 v[84:87], v3, s[20:23], s49 offen offset:3072 sc1
  s_waitcnt vmcnt(0)
  v_mfma_f32_32x32x16_bf16 v[32:47], v[72:75], v[4:7], v[16:31]
  v_mfma_f32_32x32x16_bf16 v[32:47], v[76:79], v[8:11], v[32:47]
  s_nop 15
  v_exp_f32 v32, v32
  v_exp_f32 v33, v33
  v_exp_f32 v34, v34
  v_exp_f32 v35, v35
  v_exp_f32 v36, v36
  v_exp_f32 v37, v37
  v_exp_f32 v38, v38
  v_exp_f32 v39, v39
  v_exp_f32 v40, v40
  v_exp_f32 v41, v41
  v_exp_f32 v42, v42
  v_exp_f32 v43, v43
  v_exp_f32 v44, v44
  v_exp_f32 v45, v45
  v_exp_f32 v46, v46
  v_exp_f32 v47, v47
  s_nop 1
  v_cvt_pk_bf16_f32 v64, v32, v33
  v_cvt_pk_bf16_f32 v65, v34, v35
  v_cvt_pk_bf16_f32 v66, v36, v37
  v_cvt_pk_bf16_f32 v67, v38, v39
  v_cvt_pk_bf16_f32 v68, v40, v41
  v_cvt_pk_bf16_f32 v69, v42, v43
  v_cvt_pk_bf16_f32 v70, v44, v45
  v_cvt_pk_bf16_f32 v71, v46, v47
  s_nop 1
  v_mfma_f32_32x32x16_bf16 v[96:111], v[80:83], v[64:67], v[96:111]
  v_mfma_f32_32x32x16_bf16 v[96:111], v[84:87], v[68:71], v[96:111]
  v_smfmac_f32_16x16x64_bf16 v[88:91], v[168:171], v[64:71], v175
  s_add_u32 s48, s48, 4096
  s_cmp_lt_u32 s48, 262144
  s_cbranch_scc1 P2_SLOW2
  s_nop 15
  v_add_f32 v88, v88, v89
  s_nop 0
  v_rcp_f32 v89, v88
  s_nop 1
  s_branch P2_NORM
K_END:
  s_endpgm
K_LAST:
.section .rodata,"a"
.p2align 6
.amdhsa_kernel standalone__mha_block__prompt_kernel
  .amdhsa_next_free_vgpr 256
  .amdhsa_next_free_sgpr 102
  .amdhsa_accum_offset 256
  .amdhsa_group_segment_fixed_size 0
  .amdhsa_kernarg_size 48
  .amdhsa_user_sgpr_count 2
  .amdhsa_user_sgpr_kernarg_segment_ptr 1
  .amdhsa_system_sgpr_workgroup_id_x 1
.end_amdhsa_kernel
```
